```python
import torch

def _softmax(x, axis=-1):
    return torch.softmax(x, dim=axis)
def _gelu(x):
    return torch.nn.functional.gelu(x, approximate="tanh")
def _silu(x):
    return torch.nn.functional.silu(x)
def _sigmoid(x):
    return torch.sigmoid(x)
def _layernorm(x, axis=-1, eps=1e-5):
    m = x.mean(dim=axis, keepdim=True)
    v = x.var(dim=axis, keepdim=True, unbiased=False)
    return (x - m) / torch.sqrt(v + eps)
def _scatter_add(tgt, idx, src, axis=0):
    return tgt.clone().index_add_(axis, idx, src)
def _segment_sum(src, seg, n):
    out = torch.zeros((n,) + src.shape[1:], dtype=src.dtype)
    return out.index_add_(0, seg, src)
def _pad(x, pw):
    flat = tuple(v for pair in reversed(pw) for v in pair)
    return torch.nn.functional.pad(x, flat)

kernel_name = 'parallel_sum__mha_block_cached__geglu_ffn__decode'

def setup_inputs():

    _w = (lambda a: (lambda t: t.to(torch.bfloat16) if t.is_floating_point() else t)(torch.as_tensor(a)))
    def _A_setup():
        B, Sq, D = 1, 1, 640
        H, Sk, Dh = 32, 32768, 192
        return {
            "x": _w((lambda *s: torch.randn(*s, dtype=torch.bfloat16) * 0.05)(B, Sq, D)),
            "k_cache": _w((lambda *s: torch.randn(*s, dtype=torch.bfloat16) * 3.2)(B, H, Sk, Dh)),
            "v_cache": _w((lambda *s: torch.randn(*s, dtype=torch.bfloat16) * 1.6)(B, H, Sk, Dh)),
            "wq": _w((lambda *s: torch.randn(*s, dtype=torch.bfloat16) * 3.2)(D, H * Dh) * (D ** -0.5)),
            "wo": _w((lambda *s: torch.randn(*s, dtype=torch.bfloat16) * 1.6)(H * Dh, D) * ((H * Dh) ** -0.5)),
        }
    _A_in = _A_setup()

    def _B_setup():
        B, S, D, F = 1, 1, 640, 1536
        return {
            "x": _w((lambda *s: torch.randn(*s, dtype=torch.bfloat16) * 0.05)(B, S, D)),
            "w_gate": _w((lambda *s: torch.randn(*s, dtype=torch.bfloat16) * 0.05)(D, F)),
            "w_up": _w((lambda *s: torch.randn(*s, dtype=torch.bfloat16) * 0.05)(D, F)),
            "w_down": _w((lambda *s: torch.randn(*s, dtype=torch.bfloat16) * 0.05)(F, D)),
        }
    _B_in = _B_setup()

    return {
        "A_x": _A_in["x"],
        "A_k_cache": _A_in["k_cache"],
        "A_v_cache": _A_in["v_cache"],
        "A_wq": _A_in["wq"],
        "A_wo": _A_in["wo"],
        "B_x": _B_in["x"],
        "B_w_gate": _B_in["w_gate"],
        "B_w_up": _B_in["w_up"],
        "B_w_down": _B_in["w_down"],
    }

def reference(A_x, A_k_cache, A_v_cache, A_wq, A_wo, B_x, B_w_gate, B_w_up, B_w_down):
    def _A_ref(x, k_cache, v_cache, wq, wo):
        B, Sq, D = x.shape
        H, Dh = 32, 192
        q = (lambda x, *d: x.permute(*d))((x @ wq).reshape(B, Sq, H, Dh), 0, 2, 1, 3)
        scores = torch.einsum("bhqd,bhkd->bhqk", q, k_cache) * (Dh ** -0.5)
        p = _softmax(scores, axis=-1)
        o = torch.einsum("bhqk,bhkd->bhqd", p, v_cache)
        return (lambda x, *d: x.permute(*d))(o, 0, 2, 1, 3).reshape(B, Sq, H * Dh) @ wo

    def _B_ref(x, w_gate, w_up, w_down):
        return (_gelu(x @ w_gate) * (x @ w_up)) @ w_down

    x = A_x
    xn = _layernorm(x, axis=-1)
    return x + _A_ref(xn, A_k_cache, A_v_cache, A_wq, A_wo) + _B_ref(xn, B_w_gate, B_w_up, B_w_down)
```

```asm
; @launch grid=(256,1,1) block=(512,1,1) lds=163264
.amdgcn_target "amdgcn-amd-amdhsa--gfx950"
.text
.globl parallel_sum__mha_block_cached__geglu_ffn__decode_kernel
.p2align 8
.type parallel_sum__mha_block_cached__geglu_ffn__decode_kernel,@function
parallel_sum__mha_block_cached__geglu_ffn__decode_kernel:
    s_cmp_ge_u32 s2, 256
    s_cbranch_scc1 L_end
    v_lshrrev_b32 v1, 6, v0
    v_mov_b32 v7, 163200
    v_readfirstlane_b32 s3, v1
    v_and_b32 v1, 63, v0
    v_and_b32 v4, 7, v1
    s_lshr_b32 s66, s2, 3
    s_cmp_lg_u32 s3, 7
    s_cbranch_scc1 L_args
    v_mov_b32 v6, 0
    v_lshl_add_u32 v5, v4, 2, v7
    ds_write_b32 v5, v6
    s_getpc_b64 s[28:29]
L_pca:
    s_sub_u32 s28, s28, L_pca-parallel_sum__mha_block_cached__geglu_ffn__decode_kernel
    s_subb_u32 s29, s29, 0
    s_and_b32 s30, s66, 3
    s_lshl_b32 s30, s30, 13
    v_lshl_add_u32 v20, v1, 7, s30
    s_mov_b32 s30, L_end-parallel_sum__mha_block_cached__geglu_ffn__decode_kernel
    v_min_u32 v20, s30, v20
    v_mov_b32 v21, s29
    v_add_co_u32 v20, vcc, s28, v20
    s_nop 1
    v_addc_co_u32 v21, vcc, 0, v21, vcc
    global_load_dword v19, v[20:21], off
    s_waitcnt lgkmcnt(0)
L_args:
    s_load_dwordx16 s[4:19], s[0:1], 0
    s_load_dwordx8 s[20:27], s[0:1], 64
    s_barrier
    v_lshrrev_b32 v3, 3, v1
    s_mov_b32 s62, 4194304
    s_and_b32 s60, s2, 31
    s_lshr_b32 s61, s2, 5
    s_and_b32 s63, s2, 7
    s_lshl_b32 s75, s63, 2
    s_lshr_b32 s67, s60, 3
    s_add_u32 s75, s75, s67
    s_cmp_lg_u32 s3, 4
    s_cbranch_scc1 L_notq0
    s_setprio 2
    v_mul_u32_u24 v2, 12288, v3
    v_lshl_add_u32 v2, v4, 4, v2
    v_lshlrev_b32 v5, 4, v1
    v_lshlrev_b32 v6, 2, v1
    s_mul_i32 s67, s61, 983040
    s_mul_i32 s68, s60, 384
    s_add_u32 s67, s67, s68
    s_mov_b32 s46, 7864320
    s_mov_b32 s47, 0x20000
    s_mov_b32 s50, 1280
    s_mov_b32 s51, 0x20000
    s_waitcnt lgkmcnt(0)
    s_mov_b64 s[48:49], s[4:5]
    s_mov_b64 s[44:45], s[10:11]
    buffer_load_dwordx4 v[52:55], v5, s[48:51], 0 offen
    buffer_load_dword v56, v6, s[48:51], 0 offen offset:1024
    buffer_load_dwordx4 v[64:67], v2, s[44:47], s67 offen offset:0 nt
    buffer_load_dwordx4 v[68:71], v2, s[44:47], s67 offen offset:128 nt
    buffer_load_dwordx4 v[72:75], v2, s[44:47], s67 offen offset:256 nt
    s_add_u32 s67, s67, 98304
    buffer_load_dwordx4 v[76:79], v2, s[44:47], s67 offen offset:0 nt
    buffer_load_dwordx4 v[80:83], v2, s[44:47], s67 offen offset:128 nt
    buffer_load_dwordx4 v[84:87], v2, s[44:47], s67 offen offset:256 nt
    s_add_u32 s67, s67, 98304
    buffer_load_dwordx4 v[88:91], v2, s[44:47], s67 offen offset:0 nt
    buffer_load_dwordx4 v[92:95], v2, s[44:47], s67 offen offset:128 nt
    buffer_load_dwordx4 v[96:99], v2, s[44:47], s67 offen offset:256 nt
    s_add_u32 s67, s67, 98304
    buffer_load_dwordx4 v[100:103], v2, s[44:47], s67 offen offset:0 nt
    buffer_load_dwordx4 v[104:107], v2, s[44:47], s67 offen offset:128 nt
    buffer_load_dwordx4 v[108:111], v2, s[44:47], s67 offen offset:256 nt
    s_add_u32 s67, s67, 98304
    buffer_load_dwordx4 v[112:115], v2, s[44:47], s67 offen offset:0 nt
    buffer_load_dwordx4 v[116:119], v2, s[44:47], s67 offen offset:128 nt
    buffer_load_dwordx4 v[120:123], v2, s[44:47], s67 offen offset:256 nt
    s_add_u32 s67, s67, 98304
    buffer_load_dwordx4 v[124:127], v2, s[44:47], s67 offen offset:0 nt
    buffer_load_dwordx4 v[128:131], v2, s[44:47], s67 offen offset:128 nt
    buffer_load_dwordx4 v[132:135], v2, s[44:47], s67 offen offset:256 nt
    s_add_u32 s67, s67, 98304
    buffer_load_dwordx4 v[136:139], v2, s[44:47], s67 offen offset:0 nt
    buffer_load_dwordx4 v[140:143], v2, s[44:47], s67 offen offset:128 nt
    buffer_load_dwordx4 v[144:147], v2, s[44:47], s67 offen offset:256 nt
    s_add_u32 s67, s67, 98304
    buffer_load_dwordx4 v[148:151], v2, s[44:47], s67 offen offset:0 nt
    buffer_load_dwordx4 v[152:155], v2, s[44:47], s67 offen offset:128 nt
    buffer_load_dwordx4 v[156:159], v2, s[44:47], s67 offen offset:256 nt
    s_add_u32 s67, s67, 98304
    buffer_load_dwordx4 v[160:163], v2, s[44:47], s67 offen offset:0 nt
    buffer_load_dwordx4 v[164:167], v2, s[44:47], s67 offen offset:128 nt
    buffer_load_dwordx4 v[168:171], v2, s[44:47], s67 offen offset:256 nt
    s_add_u32 s67, s67, 98304
    buffer_load_dwordx4 v[172:175], v2, s[44:47], s67 offen offset:0 nt
    buffer_load_dwordx4 v[176:179], v2, s[44:47], s67 offen offset:128 nt
    buffer_load_dwordx4 v[180:183], v2, s[44:47], s67 offen offset:256 nt
    s_branch L_helper
L_notq0:
    s_cmp_lg_u32 s3, 0
    s_cbranch_scc1 L_notload
    s_setprio 3
    v_add_u32 v12, 0, v1
    v_mul_u32_u24 v5, 10923, v12
    v_lshrrev_b32 v5, 16, v5
    v_mul_u32_u24 v6, 6, v5
    v_sub_u32 v6, v12, v6
    v_mul_u32_u24 v5, 3072, v5
    v_lshl_add_u32 v21, v6, 4, v5
    v_add_u32 v12, 64, v1
    v_mul_u32_u24 v5, 10923, v12
    v_lshrrev_b32 v5, 16, v5
    v_mul_u32_u24 v6, 6, v5
    v_sub_u32 v6, v12, v6
    v_mul_u32_u24 v5, 3072, v5
    v_lshl_add_u32 v22, v6, 4, v5
    v_add_u32 v12, 128, v1
    v_mul_u32_u24 v5, 10923, v12
    v_lshrrev_b32 v5, 16, v5
    v_mul_u32_u24 v6, 6, v5
    v_sub_u32 v6, v12, v6
    v_mul_u32_u24 v5, 3072, v5
    v_lshl_add_u32 v23, v6, 4, v5
    s_mul_i32 s67, s61, 245760
    s_mul_i32 s68, s75, 96
    s_add_u32 s67, s67, s68
    s_mov_b32 s46, 1966080
    s_mov_b32 s47, 0x20000
    s_mov_b32 s50, 1966080
    s_mov_b32 s51, 0x20000
    s_waitcnt lgkmcnt(0)
    s_mov_b64 s[44:45], s[16:17]
    s_mov_b64 s[48:49], s[18:19]
    s_mov_b32 m0, 136704
    s_waitcnt vmcnt(23)
    buffer_load_dwordx4 v21, s[44:47], s67 offen nt lds
    s_mov_b32 m0, 144384
    s_waitcnt vmcnt(23)
    buffer_load_dwordx4 v21, s[48:51], s67 offen nt lds
    s_mov_b32 m0, 137728
    s_waitcnt vmcnt(23)
    buffer_load_dwordx4 v22, s[44:47], s67 offen nt lds
    s_mov_b32 m0, 145408
    s_waitcnt vmcnt(23)
    buffer_load_dwordx4 v22, s[48:51], s67 offen nt lds
    s_mov_b32 m0, 138752
    s_waitcnt vmcnt(23)
    buffer_load_dwordx4 v23, s[44:47], s67 offen nt lds
    s_mov_b32 m0, 146432
    s_waitcnt vmcnt(23)
    buffer_load_dwordx4 v23, s[48:51], s67 offen nt lds
    s_add_u32 s67, s67, 98304
    s_mov_b32 m0, 139776
    s_waitcnt vmcnt(23)
    buffer_load_dwordx4 v21, s[44:47], s67 offen nt lds
    s_mov_b32 m0, 147456
    s_waitcnt vmcnt(23)
    buffer_load_dwordx4 v21, s[48:51], s67 offen nt lds
    s_mov_b32 m0, 140800
    s_waitcnt vmcnt(23)
    buffer_load_dwordx4 v22, s[44:47], s67 offen nt lds
    s_mov_b32 m0, 148480
    s_waitcnt vmcnt(23)
    buffer_load_dwordx4 v22, s[48:51], s67 offen nt lds
    s_mov_b32 m0, 141824
    s_waitcnt vmcnt(23)
    buffer_load_dwordx4 v23, s[44:47], s67 offen nt lds
    s_mov_b32 m0, 149504
    s_waitcnt vmcnt(23)
    buffer_load_dwordx4 v23, s[48:51], s67 offen nt lds
    s_add_u32 s67, s67, 98304
    s_mov_b32 m0, 142848
    s_waitcnt vmcnt(23)
    buffer_load_dwordx4 v21, s[44:47], s67 offen nt lds
    s_mov_b32 m0, 150528
    s_waitcnt vmcnt(23)
    buffer_load_dwordx4 v21, s[48:51], s67 offen nt lds
    s_mov_b32 exec_hi, 0
    s_mov_b32 m0, 143872
    s_waitcnt vmcnt(23)
    buffer_load_dwordx4 v22, s[44:47], s67 offen nt lds
    s_mov_b32 exec_hi, -1
    s_mov_b32 exec_hi, 0
    s_mov_b32 m0, 151552
    s_waitcnt vmcnt(23)
    buffer_load_dwordx4 v22, s[48:51], s67 offen nt lds
    s_mov_b32 exec_hi, -1
    v_add_u32 v12, 0, v1
    v_mul_u32_u24 v5, 6554, v12
    v_lshrrev_b32 v5, 16, v5
    v_mul_u32_u24 v6, 10, v5
    v_sub_u32 v6, v12, v6
    v_mul_u32_u24 v5, 1280, v5
    v_lshl_add_u32 v16, v6, 4, v5
    v_add_u32 v12, 64, v1
    v_mul_u32_u24 v5, 6554, v12
    v_lshrrev_b32 v5, 16, v5
    v_mul_u32_u24 v6, 10, v5
    v_sub_u32 v6, v12, v6
    v_mul_u32_u24 v5, 1280, v5
    v_lshl_add_u32 v17, v6, 4, v5
    v_add_u32 v12, 128, v1
    v_mul_u32_u24 v5, 6554, v12
    v_lshrrev_b32 v5, 16, v5
    v_mul_u32_u24 v6, 10, v5
    v_sub_u32 v6, v12, v6
    v_mul_u32_u24 v5, 1280, v5
    v_lshl_add_u32 v18, v6, 4, v5
    v_add_u32 v12, 192, v1
    v_mul_u32_u24 v5, 6554, v12
    v_lshrrev_b32 v5, 16, v5
    v_mul_u32_u24 v6, 10, v5
    v_sub_u32 v6, v12, v6
    v_mul_u32_u24 v5, 1280, v5
    v_lshl_add_u32 v19, v6, 4, v5
    v_add_u32 v12, 256, v1
    v_mul_u32_u24 v5, 6554, v12
    v_lshrrev_b32 v5, 16, v5
    v_mul_u32_u24 v6, 10, v5
    v_sub_u32 v6, v12, v6
    v_mul_u32_u24 v5, 1280, v5
    v_lshl_add_u32 v20, v6, 4, v5
    v_mul_u32_u24 v12, 384, v3
    v_lshrrev_b32 v13, 1, v3
    v_xor_b32 v13, v13, v4
    v_lshl_add_u32 v24, v13, 4, v12
    v_xor_b32 v25, 64, v24
    v_and_b32 v13, 2, v3
    v_xor_b32 v13, v13, v4
    v_lshl_add_u32 v26, v13, 4, v12
    v_xor_b32 v27, 64, v26
    s_mov_b32 s44, s20
    s_mov_b32 s45, s21
    s_mov_b32 s46, 1966080
    s_mov_b32 s47, 0x20000
    s_mov_b32 s48, s12
    s_mov_b32 s49, s13
    s_mov_b32 s50, 7864320
    s_mov_b32 s51, 0x20000
    s_mul_i32 s67, s75, 61440
    s_mul_i32 s69, s61, 160
    s_add_u32 s67, s67, s69
    s_mov_b32 s41, s67
    s_mov_b32 m0, 129024
    s_waitcnt vmcnt(23)
    buffer_load_dwordx4 v16, s[44:47], s41 offen nt lds
    s_mov_b32 m0, 130048
    s_waitcnt vmcnt(23)
    buffer_load_dwordx4 v17, s[44:47], s41 offen nt lds
    s_mov_b32 m0, 131072
    s_waitcnt vmcnt(23)
    buffer_load_dwordx4 v18, s[44:47], s41 offen nt lds
    s_mov_b32 m0, 132096
    s_waitcnt vmcnt(23)
    buffer_load_dwordx4 v19, s[44:47], s41 offen nt lds
    s_mov_b32 m0, 133120
    s_waitcnt vmcnt(23)
    buffer_load_dwordx4 v20, s[44:47], s41 offen nt lds
    s_add_u32 s41, s41, 40960
    s_mov_b32 m0, 134144
    s_waitcnt vmcnt(23)
    buffer_load_dwordx4 v16, s[44:47], s41 offen nt lds
    s_mov_b32 m0, 135168
    s_waitcnt vmcnt(23)
    buffer_load_dwordx4 v17, s[44:47], s41 offen nt lds
    s_mov_b32 exec_hi, 0
    s_mov_b32 m0, 136192
    s_waitcnt vmcnt(23)
    buffer_load_dwordx4 v18, s[44:47], s41 offen nt lds
    s_mov_b32 exec_hi, -1
    s_mul_i32 s67, s60, 245760
    s_add_u32 s67, s67, s69
    s_mov_b32 s68, 98304
L_wo:
    s_add_u32 m0, s68, 0
    s_waitcnt vmcnt(23)
    buffer_load_dwordx4 v16, s[48:51], s67 offen nt lds
    s_add_u32 m0, s68, 1024
    s_waitcnt vmcnt(23)
    buffer_load_dwordx4 v17, s[48:51], s67 offen nt lds
    s_add_u32 m0, s68, 2048
    s_waitcnt vmcnt(23)
    buffer_load_dwordx4 v18, s[48:51], s67 offen nt lds
    s_add_u32 m0, s68, 3072
    s_waitcnt vmcnt(23)
    buffer_load_dwordx4 v19, s[48:51], s67 offen nt lds
    s_add_u32 m0, s68, 4096
    s_waitcnt vmcnt(23)
    buffer_load_dwordx4 v20, s[48:51], s67 offen nt lds
    s_add_u32 s67, s67, 40960
    s_add_u32 s68, s68, 5120
    s_cmp_lg_u32 s68, 129024
    s_cbranch_scc1 L_wo
    s_mov_b32 s28, s6
    s_mov_b32 s29, s7
    s_mov_b32 s30, 402653184
    s_mov_b32 s31, 0x20000
    s_mov_b32 s40, s66
    s_mul_i32 s32, s66, 12288
    s_mul_i32 s33, s63, 12582912
    s_mov_b32 s71, 0
    s_mov_b32 s34, 0
    s_mov_b32 s37, 0
    v_mov_b32 v12, 0
    v_mov_b32 v13, 0
    v_mov_b32 v14, 0
L_tile:
    s_waitcnt lgkmcnt(0)
    v_min_u32 v12, v12, v13
    s_add_u32 s35, s32, s33
    v_readfirstlane_b32 s67, v12
    v_readfirstlane_b32 s68, v14
    s_add_u32 s36, s35, 6144
    s_add_u32 s67, s67, 8
    s_cmp_gt_u32 s67, s71
    s_cbranch_scc1 L_go
    ds_read_b96 v[12:14], v7 offset:16
    s_sub_u32 s62, s62, 1
    s_cselect_b32 s62, 0, s62
    s_cbranch_scc0 L_tile
L_go:
    s_cmp_ge_i32 s68, 1
    s_cbranch_scc1 L_m4_7
    s_cmp_ge_i32 s68, -1
    s_cbranch_scc1 L_m2_3
    s_cmp_ge_i32 s68, -2
    s_cbranch_scc1 L_m1_1
    s_sub_u32 s67, s71, 1
    s_max_i32 s37, s37, s67
    v_mov_b32 v9, s37
    s_add_u32 m0, s34, 0
    s_waitcnt vmcnt(17)
    buffer_load_dwordx4 v24, s[28:31], s35 offen offset:0 nt lds
    s_add_u32 m0, s34, 896
    s_waitcnt vmcnt(17)
    buffer_load_dwordx4 v24, s[28:31], s35 offen offset:128 nt lds
    s_add_u32 m0, s34, 1792
    s_waitcnt vmcnt(17)
    buffer_load_dwordx4 v24, s[28:31], s35 offen offset:256 nt lds
    s_add_u32 m0, s34, 0
    s_waitcnt vmcnt(17)
    buffer_load_dwordx4 v25, s[28:31], s35 offen offset:3072 nt lds
    s_add_u32 m0, s34, 896
    s_waitcnt vmcnt(17)
    buffer_load_dwordx4 v25, s[28:31], s35 offen offset:3200 nt lds
    s_add_u32 m0, s34, 1792
    s_waitcnt vmcnt(17)
    buffer_load_dwordx4 v25, s[28:31], s35 offen offset:3328 nt lds
    ds_write_b32 v7, v9 offset:0
    s_add_u32 m0, s34, 6144
    s_waitcnt vmcnt(17)
    buffer_load_dwordx4 v24, s[28:31], s36 offen offset:0 nt lds
    s_add_u32 m0, s34, 7040
    s_waitcnt vmcnt(17)
    buffer_load_dwordx4 v24, s[28:31], s36 offen offset:128 nt lds
    s_add_u32 m0, s34, 7936
    s_waitcnt vmcnt(17)
    buffer_load_dwordx4 v24, s[28:31], s36 offen offset:256 nt lds
    s_add_u32 m0, s34, 6144
    s_waitcnt vmcnt(17)
    buffer_load_dwordx4 v25, s[28:31], s36 offen offset:3072 nt lds
    s_add_u32 m0, s34, 7040
    s_waitcnt vmcnt(17)
    buffer_load_dwordx4 v25, s[28:31], s36 offen offset:3200 nt lds
    ds_read_b96 v[12:14], v7 offset:16
    s_add_u32 m0, s34, 7936
    s_waitcnt vmcnt(17)
    buffer_load_dwordx4 v25, s[28:31], s36 offen offset:3328 nt lds
    s_branch L_adv
L_m1_1:
    s_sub_u32 s67, s71, 1
    s_max_i32 s37, s37, s67
    v_mov_b32 v9, s37
    s_add_u32 m0, s34, 0
    s_waitcnt vmcnt(18)
    buffer_load_dwordx4 v24, s[28:31], s35 offen offset:0 nt lds
    s_add_u32 m0, s34, 896
    s_waitcnt vmcnt(18)
    buffer_load_dwordx4 v24, s[28:31], s35 offen offset:128 nt lds
    s_add_u32 m0, s34, 1792
    s_waitcnt vmcnt(18)
    buffer_load_dwordx4 v24, s[28:31], s35 offen offset:256 nt lds
    s_add_u32 m0, s34, 0
    s_waitcnt vmcnt(18)
    buffer_load_dwordx4 v25, s[28:31], s35 offen offset:3072 nt lds
    s_add_u32 m0, s34, 896
    s_waitcnt vmcnt(18)
    buffer_load_dwordx4 v25, s[28:31], s35 offen offset:3200 nt lds
    s_add_u32 m0, s34, 1792
    s_waitcnt vmcnt(18)
    buffer_load_dwordx4 v25, s[28:31], s35 offen offset:3328 nt lds
    s_add_u32 m0, s34, 6144
    s_waitcnt vmcnt(18)
    buffer_load_dwordx4 v24, s[28:31], s36 offen offset:0 nt lds
    ds_write_b32 v7, v9 offset:0
    s_add_u32 m0, s34, 7040
    s_waitcnt vmcnt(18)
    buffer_load_dwordx4 v24, s[28:31], s36 offen offset:128 nt lds
    s_add_u32 m0, s34, 7936
    s_waitcnt vmcnt(18)
    buffer_load_dwordx4 v24, s[28:31], s36 offen offset:256 nt lds
    s_add_u32 m0, s34, 6144
    s_waitcnt vmcnt(18)
    buffer_load_dwordx4 v25, s[28:31], s36 offen offset:3072 nt lds
    s_add_u32 m0, s34, 7040
    s_waitcnt vmcnt(18)
    buffer_load_dwordx4 v25, s[28:31], s36 offen offset:3200 nt lds
    ds_read_b96 v[12:14], v7 offset:16
    s_add_u32 m0, s34, 7936
    s_waitcnt vmcnt(18)
    buffer_load_dwordx4 v25, s[28:31], s36 offen offset:3328 nt lds
    s_branch L_adv
L_m2_3:
    s_cmp_ge_i32 s68, 0
    s_cbranch_scc1 L_m3_3
    s_sub_u32 s67, s71, 1
    s_max_i32 s37, s37, s67
    v_mov_b32 v9, s37
    s_add_u32 m0, s34, 0
    s_waitcnt vmcnt(19)
    buffer_load_dwordx4 v24, s[28:31], s35 offen offset:0 nt lds
    s_add_u32 m0, s34, 896
    s_waitcnt vmcnt(19)
    buffer_load_dwordx4 v24, s[28:31], s35 offen offset:128 nt lds
    s_add_u32 m0, s34, 1792
    s_waitcnt vmcnt(19)
    buffer_load_dwordx4 v24, s[28:31], s35 offen offset:256 nt lds
    s_add_u32 m0, s34, 0
    s_waitcnt vmcnt(19)
    buffer_load_dwordx4 v25, s[28:31], s35 offen offset:3072 nt lds
    s_add_u32 m0, s34, 896
    s_waitcnt vmcnt(19)
    buffer_load_dwordx4 v25, s[28:31], s35 offen offset:3200 nt lds
    s_add_u32 m0, s34, 1792
    s_waitcnt vmcnt(19)
    buffer_load_dwordx4 v25, s[28:31], s35 offen offset:3328 nt lds
    s_add_u32 m0, s34, 6144
    s_waitcnt vmcnt(19)
    buffer_load_dwordx4 v24, s[28:31], s36 offen offset:0 nt lds
    s_add_u32 m0, s34, 7040
    s_waitcnt vmcnt(19)
    buffer_load_dwordx4 v24, s[28:31], s36 offen offset:128 nt lds
    ds_write_b32 v7, v9 offset:0
    s_add_u32 m0, s34, 7936
    s_waitcnt vmcnt(19)
    buffer_load_dwordx4 v24, s[28:31], s36 offen offset:256 nt lds
    s_add_u32 m0, s34, 6144
    s_waitcnt vmcnt(19)
    buffer_load_dwordx4 v25, s[28:31], s36 offen offset:3072 nt lds
    s_add_u32 m0, s34, 7040
    s_waitcnt vmcnt(19)
    buffer_load_dwordx4 v25, s[28:31], s36 offen offset:3200 nt lds
    ds_read_b96 v[12:14], v7 offset:16
    s_add_u32 m0, s34, 7936
    s_waitcnt vmcnt(19)
    buffer_load_dwordx4 v25, s[28:31], s36 offen offset:3328 nt lds
    s_branch L_adv
L_m3_3:
    s_sub_u32 s67, s71, 1
    s_max_i32 s37, s37, s67
    v_mov_b32 v9, s37
    s_add_u32 m0, s34, 0
    s_waitcnt vmcnt(20)
    buffer_load_dwordx4 v24, s[28:31], s35 offen offset:0 nt lds
    s_add_u32 m0, s34, 896
    s_waitcnt vmcnt(20)
    buffer_load_dwordx4 v24, s[28:31], s35 offen offset:128 nt lds
    s_add_u32 m0, s34, 1792
    s_waitcnt vmcnt(20)
    buffer_load_dwordx4 v24, s[28:31], s35 offen offset:256 nt lds
    s_add_u32 m0, s34, 0
    s_waitcnt vmcnt(20)
    buffer_load_dwordx4 v25, s[28:31], s35 offen offset:3072 nt lds
    s_add_u32 m0, s34, 896
    s_waitcnt vmcnt(20)
    buffer_load_dwordx4 v25, s[28:31], s35 offen offset:3200 nt lds
    s_add_u32 m0, s34, 1792
    s_waitcnt vmcnt(20)
    buffer_load_dwordx4 v25, s[28:31], s35 offen offset:3328 nt lds
    s_add_u32 m0, s34, 6144
    s_waitcnt vmcnt(20)
    buffer_load_dwordx4 v24, s[28:31], s36 offen offset:0 nt lds
    s_add_u32 m0, s34, 7040
    s_waitcnt vmcnt(20)
    buffer_load_dwordx4 v24, s[28:31], s36 offen offset:128 nt lds
    s_add_u32 m0, s34, 7936
    s_waitcnt vmcnt(20)
    buffer_load_dwordx4 v24, s[28:31], s36 offen offset:256 nt lds
    ds_write_b32 v7, v9 offset:0
    s_add_u32 m0, s34, 6144
    s_waitcnt vmcnt(20)
    buffer_load_dwordx4 v25, s[28:31], s36 offen offset:3072 nt lds
    s_add_u32 m0, s34, 7040
    s_waitcnt vmcnt(20)
    buffer_load_dwordx4 v25, s[28:31], s36 offen offset:3200 nt lds
    ds_read_b96 v[12:14], v7 offset:16
    s_add_u32 m0, s34, 7936
    s_waitcnt vmcnt(20)
    buffer_load_dwordx4 v25, s[28:31], s36 offen offset:3328 nt lds
    s_branch L_adv
L_m4_7:
    s_cmp_ge_i32 s68, 3
    s_cbranch_scc1 L_m6_7
    s_cmp_ge_i32 s68, 2
    s_cbranch_scc1 L_m5_5
    s_sub_u32 s67, s71, 1
    s_max_i32 s37, s37, s67
    v_mov_b32 v9, s37
    s_add_u32 m0, s34, 0
    s_waitcnt vmcnt(21)
    buffer_load_dwordx4 v24, s[28:31], s35 offen offset:0 nt lds
    s_add_u32 m0, s34, 896
    s_waitcnt vmcnt(21)
    buffer_load_dwordx4 v24, s[28:31], s35 offen offset:128 nt lds
    s_add_u32 m0, s34, 1792
    s_waitcnt vmcnt(21)
    buffer_load_dwordx4 v24, s[28:31], s35 offen offset:256 nt lds
    s_add_u32 m0, s34, 0
    s_waitcnt vmcnt(21)
    buffer_load_dwordx4 v25, s[28:31], s35 offen offset:3072 nt lds
    s_add_u32 m0, s34, 896
    s_waitcnt vmcnt(21)
    buffer_load_dwordx4 v25, s[28:31], s35 offen offset:3200 nt lds
    s_add_u32 m0, s34, 1792
    s_waitcnt vmcnt(21)
    buffer_load_dwordx4 v25, s[28:31], s35 offen offset:3328 nt lds
    s_add_u32 m0, s34, 6144
    s_waitcnt vmcnt(21)
    buffer_load_dwordx4 v24, s[28:31], s36 offen offset:0 nt lds
    s_add_u32 m0, s34, 7040
    s_waitcnt vmcnt(21)
    buffer_load_dwordx4 v24, s[28:31], s36 offen offset:128 nt lds
    s_add_u32 m0, s34, 7936
    s_waitcnt vmcnt(21)
    buffer_load_dwordx4 v24, s[28:31], s36 offen offset:256 nt lds
    s_add_u32 m0, s34, 6144
    s_waitcnt vmcnt(21)
    buffer_load_dwordx4 v25, s[28:31], s36 offen offset:3072 nt lds
    ds_write_b32 v7, v9 offset:0
    s_add_u32 m0, s34, 7040
    s_waitcnt vmcnt(21)
    buffer_load_dwordx4 v25, s[28:31], s36 offen offset:3200 nt lds
    ds_read_b96 v[12:14], v7 offset:16
    s_add_u32 m0, s34, 7936
    s_waitcnt vmcnt(21)
    buffer_load_dwordx4 v25, s[28:31], s36 offen offset:3328 nt lds
    s_branch L_adv
L_m5_5:
    s_sub_u32 s67, s71, 1
    s_max_i32 s37, s37, s67
    v_mov_b32 v9, s37
    s_add_u32 m0, s34, 0
    s_waitcnt vmcnt(22)
    buffer_load_dwordx4 v24, s[28:31], s35 offen offset:0 nt lds
    s_add_u32 m0, s34, 896
    s_waitcnt vmcnt(22)
    buffer_load_dwordx4 v24, s[28:31], s35 offen offset:128 nt lds
    s_add_u32 m0, s34, 1792
    s_waitcnt vmcnt(22)
    buffer_load_dwordx4 v24, s[28:31], s35 offen offset:256 nt lds
    s_add_u32 m0, s34, 0
    s_waitcnt vmcnt(22)
    buffer_load_dwordx4 v25, s[28:31], s35 offen offset:3072 nt lds
    s_add_u32 m0, s34, 896
    s_waitcnt vmcnt(22)
    buffer_load_dwordx4 v25, s[28:31], s35 offen offset:3200 nt lds
    s_add_u32 m0, s34, 1792
    s_waitcnt vmcnt(22)
    buffer_load_dwordx4 v25, s[28:31], s35 offen offset:3328 nt lds
    s_add_u32 m0, s34, 6144
    s_waitcnt vmcnt(22)
    buffer_load_dwordx4 v24, s[28:31], s36 offen offset:0 nt lds
    s_add_u32 m0, s34, 7040
    s_waitcnt vmcnt(22)
    buffer_load_dwordx4 v24, s[28:31], s36 offen offset:128 nt lds
    s_add_u32 m0, s34, 7936
    s_waitcnt vmcnt(22)
    buffer_load_dwordx4 v24, s[28:31], s36 offen offset:256 nt lds
    s_add_u32 m0, s34, 6144
    s_waitcnt vmcnt(22)
    buffer_load_dwordx4 v25, s[28:31], s36 offen offset:3072 nt lds
    s_add_u32 m0, s34, 7040
    s_waitcnt vmcnt(22)
    buffer_load_dwordx4 v25, s[28:31], s36 offen offset:3200 nt lds
    ds_write_b32 v7, v9 offset:0
    ds_read_b96 v[12:14], v7 offset:16
    s_add_u32 m0, s34, 7936
    s_waitcnt vmcnt(22)
    buffer_load_dwordx4 v25, s[28:31], s36 offen offset:3328 nt lds
    s_branch L_adv
L_m6_7:
    s_cmp_ge_i32 s68, 4
    s_cbranch_scc1 L_m7_7
    s_sub_u32 s67, s71, 2
    s_max_i32 s37, s37, s67
    v_mov_b32 v9, s37
    s_add_u32 m0, s34, 0
    s_waitcnt vmcnt(24)
    buffer_load_dwordx4 v24, s[28:31], s35 offen offset:0 nt lds
    ds_write_b32 v7, v9 offset:0
    s_add_u32 m0, s34, 896
    s_waitcnt vmcnt(24)
    buffer_load_dwordx4 v24, s[28:31], s35 offen offset:128 nt lds
    s_add_u32 m0, s34, 1792
    s_waitcnt vmcnt(24)
    buffer_load_dwordx4 v24, s[28:31], s35 offen offset:256 nt lds
    s_add_u32 m0, s34, 0
    s_waitcnt vmcnt(24)
    buffer_load_dwordx4 v25, s[28:31], s35 offen offset:3072 nt lds
    s_add_u32 m0, s34, 896
    s_waitcnt vmcnt(24)
    buffer_load_dwordx4 v25, s[28:31], s35 offen offset:3200 nt lds
    s_add_u32 m0, s34, 1792
    s_waitcnt vmcnt(24)
    buffer_load_dwordx4 v25, s[28:31], s35 offen offset:3328 nt lds
    s_add_u32 m0, s34, 6144
    s_waitcnt vmcnt(24)
    buffer_load_dwordx4 v24, s[28:31], s36 offen offset:0 nt lds
    s_add_u32 m0, s34, 7040
    s_waitcnt vmcnt(24)
    buffer_load_dwordx4 v24, s[28:31], s36 offen offset:128 nt lds
    s_add_u32 m0, s34, 7936
    s_waitcnt vmcnt(24)
    buffer_load_dwordx4 v24, s[28:31], s36 offen offset:256 nt lds
    s_add_u32 m0, s34, 6144
    s_waitcnt vmcnt(24)
    buffer_load_dwordx4 v25, s[28:31], s36 offen offset:3072 nt lds
    s_add_u32 m0, s34, 7040
    s_waitcnt vmcnt(24)
    buffer_load_dwordx4 v25, s[28:31], s36 offen offset:3200 nt lds
    ds_read_b96 v[12:14], v7 offset:16
    s_add_u32 m0, s34, 7936
    s_waitcnt vmcnt(24)
    buffer_load_dwordx4 v25, s[28:31], s36 offen offset:3328 nt lds
    s_branch L_adv
L_m7_7:
    s_sub_u32 s67, s71, 2
    s_max_i32 s37, s37, s67
    v_mov_b32 v9, s37
    s_add_u32 m0, s34, 0
    s_waitcnt vmcnt(27)
    buffer_load_dwordx4 v24, s[28:31], s35 offen offset:0 nt lds
    s_add_u32 m0, s34, 896
    s_waitcnt vmcnt(27)
    buffer_load_dwordx4 v24, s[28:31], s35 offen offset:128 nt lds
    s_add_u32 m0, s34, 1792
    s_waitcnt vmcnt(27)
    buffer_load_dwordx4 v24, s[28:31], s35 offen offset:256 nt lds
    s_add_u32 m0, s34, 0
    s_waitcnt vmcnt(27)
    buffer_load_dwordx4 v25, s[28:31], s35 offen offset:3072 nt lds
    ds_write_b32 v7, v9 offset:0
    s_add_u32 m0, s34, 896
    s_waitcnt vmcnt(27)
    buffer_load_dwordx4 v25, s[28:31], s35 offen offset:3200 nt lds
    s_add_u32 m0, s34, 1792
    s_waitcnt vmcnt(27)
    buffer_load_dwordx4 v25, s[28:31], s35 offen offset:3328 nt lds
    s_add_u32 m0, s34, 6144
    s_waitcnt vmcnt(27)
    buffer_load_dwordx4 v24, s[28:31], s36 offen offset:0 nt lds
    s_add_u32 m0, s34, 7040
    s_waitcnt vmcnt(27)
    buffer_load_dwordx4 v24, s[28:31], s36 offen offset:128 nt lds
    s_add_u32 m0, s34, 7936
    s_waitcnt vmcnt(27)
    buffer_load_dwordx4 v24, s[28:31], s36 offen offset:256 nt lds
    s_add_u32 m0, s34, 6144
    s_waitcnt vmcnt(27)
    buffer_load_dwordx4 v25, s[28:31], s36 offen offset:3072 nt lds
    s_add_u32 m0, s34, 7040
    s_waitcnt vmcnt(27)
    buffer_load_dwordx4 v25, s[28:31], s36 offen offset:3200 nt lds
    ds_read_b96 v[12:14], v7 offset:16
    s_add_u32 m0, s34, 7936
    s_waitcnt vmcnt(27)
    buffer_load_dwordx4 v25, s[28:31], s36 offen offset:3328 nt lds
L_adv:
    s_add_u32 s40, s40, 1
    s_cmp_ge_u32 s40, 32
    s_cselect_b32 s67, 0, 393216
    s_and_b32 s40, s40, 31
    s_add_u32 s32, s32, s67
    s_add_u32 s32, s32, 12288
    s_cmp_ge_u32 s32, 12582912
    s_cselect_b32 s67, 12582912, 0
    s_sub_u32 s32, s32, s67
    s_add_u32 s71, s71, 1
    s_and_b32 s67, s71, 7
    s_mul_i32 s34, s67, 12288
    s_and_b32 s67, s71, 31
    s_cselect_b32 s67, 0, 100663296
    s_add_u32 s33, s33, s67
    s_cmp_lg_u32 s71, 128
    s_cbranch_scc1 L_nosw
    s_mul_i32 s33, s63, 12582912
    s_mov_b64 s[28:29], s[8:9]
    v_mov_b32 v24, v26
    v_mov_b32 v25, v27
L_nosw:
    s_cmp_lt_u32 s71, 256
    s_cbranch_scc1 L_tile
    s_max_i32 s37, s37, 254
    v_mov_b32 v9, s37
    s_waitcnt vmcnt(24)
    ds_write_b32 v7, v9 offset:0
    s_max_i32 s37, s37, 255
    v_mov_b32 v9, s37
    s_waitcnt vmcnt(12)
    ds_write_b32 v7, v9 offset:0
    s_max_i32 s37, s37, 256
    v_mov_b32 v9, s37
    s_waitcnt vmcnt(0)
    ds_write_b32 v7, v9 offset:0
    s_waitcnt lgkmcnt(0)
    s_endpgm
L_notload:
    s_cmp_gt_u32 s3, 2
    s_cbranch_scc1 L_helper
    s_setprio 1
    s_sub_u32 s32, s3, 1
    v_lshrrev_b32 v88, 4, v1
    v_and_b32 v89, 15, v1
    v_lshrrev_b32 v90, 1, v89
    v_xor_b32 v90, v90, v88
    v_lshlrev_b32 v90, 4, v90
    v_lshl_add_u32 v90, v4, 7, v90
    v_bfe_u32 v91, v1, 3, 1
    v_mul_u32_u24 v91, 3072, v91
    s_mul_i32 s67, s32, 6144
    v_add3_u32 v92, v90, v91, s67
    v_xor_b32 v93, 64, v92
    s_lshl_b32 s67, s32, 5
    s_add_u32 s67, s67, 152064
    v_lshl_add_u32 v94, v89, 1, s67
    v_lshlrev_b32 v95, 4, v88
    v_add_u32 v95, 160256, v95
    s_lshl_b32 s67, s32, 2
    v_add_u32 v96, s67, v7
    s_mov_b32 s71, 0
    s_mov_b32 s33, 0
    s_mov_b32 s72, 0
    s_waitcnt lgkmcnt(0)
    s_mov_b32 s56, s26
    s_mov_b32 s57, s27
    s_mov_b32 s58, 1449984
    s_mov_b32 s59, 0x20000
L_kgrp:
L_qw:
    ds_read_b32 v100, v7 offset:4
    s_waitcnt lgkmcnt(0)
    v_readfirstlane_b32 s70, v100
    s_cmp_gt_u32 s70, s72
    s_cbranch_scc1 L_qw_d
    s_sleep 1
    s_sub_u32 s62, s62, 2
    s_cselect_b32 s62, 0, s62
    s_cbranch_scc0 L_qw
L_qw_d:
    ds_read_b128 v[16:19], v95 offset:0
    ds_read_b128 v[20:23], v95 offset:64
    ds_read_b128 v[24:27], v95 offset:128
    ds_read_b128 v[28:31], v95 offset:192
    ds_read_b128 v[32:35], v95 offset:256
    ds_read_b128 v[36:39], v95 offset:320
    v_add_u32 v95, 384, v95
L_ktile:
    s_and_b32 s34, s71, 7
    s_mul_i32 s34, s34, 12288
    s_add_u32 s67, s71, 1
    v_add_u32 v98, s34, v92
    v_add_u32 v99, s34, v93
    v_mov_b32 v97, s67
    s_cmp_gt_u32 s33, s71
    s_cbranch_scc1 L_ldk_d
L_ldk:
    ds_read_b32 v100, v7 offset:0
    s_waitcnt lgkmcnt(0)
    v_readfirstlane_b32 s33, v100
    s_cmp_gt_u32 s33, s71
    s_cbranch_scc1 L_ldk_d
    s_sub_u32 s62, s62, 1
    s_cselect_b32 s62, 0, s62
    s_cbranch_scc0 L_ldk
L_ldk_d:
    ds_read_b128 v[40:43], v98 offset:0
    ds_read_b128 v[44:47], v99 offset:0
    ds_read_b128 v[48:51], v98 offset:1024
    ds_read_b128 v[52:55], v99 offset:1024
    ds_read_b128 v[56:59], v98 offset:2048
    ds_read_b128 v[60:63], v99 offset:2048
    s_waitcnt lgkmcnt(5)
    v_mfma_f32_16x16x32_bf16 v[8:11], v[16:19], v[40:43], 0
    s_waitcnt lgkmcnt(4)
    v_mfma_f32_16x16x32_bf16 v[8:11], v[20:23], v[44:47], v[8:11]
    s_waitcnt lgkmcnt(3)
    v_mfma_f32_16x16x32_bf16 v[8:11], v[24:27], v[48:51], v[8:11]
    s_waitcnt lgkmcnt(2)
    v_mfma_f32_16x16x32_bf16 v[8:11], v[28:31], v[52:55], v[8:11]
    s_waitcnt lgkmcnt(1)
    v_mfma_f32_16x16x32_bf16 v[8:11], v[32:35], v[56:59], v[8:11]
    s_waitcnt lgkmcnt(0)
    ds_write_b32 v96, v97 offset:16
    v_mfma_f32_16x16x32_bf16 v[8:11], v[36:39], v[60:63], v[8:11]
    s_add_u32 s71, s71, 1
    s_nop 6
    v_cvt_pk_bf16_f32 v12, v8, v8
    v_and_b32 v12, 0xffff0000, v12
    v_mul_f32 v12, 0x3d93cd3a, v12
    v_cvt_pk_bf16_f32 v12, v12, v12
    ds_write_b16 v94, v12
    v_add_u32 v94, 64, v94
    s_and_b32 s67, s71, 31
    s_cbranch_scc1 L_ktile
    s_add_u32 s72, s72, 1
    s_cmp_lt_u32 s72, 4
    s_cbranch_scc1 L_kgrp
    ds_read_b32 v100, v7 offset:28
    s_waitcnt lgkmcnt(0)
    v_readfirstlane_b32 s74, v100
    s_and_b32 s73, s74, 0xff
    v_bfe_u32 v90, v1, 2, 2
    v_and_b32 v91, 2, v90
    v_and_b32 v92, 1, v88
    v_lshl_add_u32 v91, v92, 2, v91
    v_bfe_u32 v92, v1, 1, 1
    s_lshl_b32 s67, s32, 2
    v_add_u32 v92, s67, v92
    v_xor_b32 v91, v91, v92
    v_lshlrev_b32 v91, 4, v91
    v_lshl_add_u32 v91, v90, 7, v91
    v_and_b32 v92, 1, v1
    v_lshl_add_u32 v91, v92, 3, v91
    v_mul_u32_u24 v92, 3072, v88
    v_add_u32 v92, v91, v92
    v_xor_b32 v93, 32, v92
    v_lshlrev_b32 v94, 4, v88
    v_add_u32 v94, 152064, v94
    v_lshlrev_b32 v95, 11, v88
    v_lshl_add_u32 v95, v90, 8, v95
    v_and_b32 v90, 3, v1
    v_lshl_add_u32 v95, v90, 2, v95
    v_cmp_eq_u32 s[36:37], 1, v88
    v_cmp_eq_u32 s[38:39], 2, v88
    s_mul_i32 s35, s63, 12288
    s_lshr_b32 s67, s66, 4
    s_mul_i32 s67, s67, 6144
    s_add_u32 s35, s35, s67
    s_and_b32 s67, s66, 15
    s_lshl_b32 s67, s67, 4
    s_add_u32 s35, s35, s67
    s_lshl_b32 s67, s32, 10
    s_add_u32 s35, s35, s67
    s_lshl_b32 s40, s63, 8
    s_lshl_b32 s67, s66, 3
    s_add_u32 s40, s40, s67
    s_lshl_b32 s67, s32, 2
    s_add_u32 s40, s40, s67
    s_add_u32 s40, s40, 1441792
    v_mov_b32 v101, s74
    s_mov_b32 s72, 0
    ds_read_b32 v100, v7 offset:12
    s_waitcnt lgkmcnt(0)
    v_readfirstlane_b32 s54, v100
L_vgrp:
L_pw:
    ds_read_b32 v100, v7 offset:8
    s_waitcnt lgkmcnt(0)
    v_readfirstlane_b32 s70, v100
    s_cmp_gt_u32 s70, s72
    s_cbranch_scc1 L_pw_d
    s_sleep 1
    s_sub_u32 s62, s62, 2
    s_cselect_b32 s62, 0, s62
    s_cbranch_scc0 L_pw
L_pw_d:
    v_mov_b32 v64, 0
    v_mov_b32 v65, 0
    v_mov_b32 v66, 0
    v_mov_b32 v67, 0
    v_mov_b32 v68, 0
    v_mov_b32 v69, 0
    v_mov_b32 v70, 0
    v_mov_b32 v71, 0
    v_mov_b32 v72, 0
    v_mov_b32 v73, 0
    v_mov_b32 v74, 0
    v_mov_b32 v75, 0
    v_mov_b32 v76, 0
    v_mov_b32 v77, 0
    v_mov_b32 v78, 0
    v_mov_b32 v79, 0
    v_mov_b32 v80, 0
    v_mov_b32 v81, 0
    v_mov_b32 v82, 0
    v_mov_b32 v83, 0
    v_mov_b32 v84, 0
    v_mov_b32 v85, 0
    v_mov_b32 v86, 0
    v_mov_b32 v87, 0
L_vtile:
    ds_read_b128 v[12:15], v94
    v_add_u32 v94, 64, v94
    s_and_b32 s34, s71, 7
    s_mul_i32 s34, s34, 12288
    s_add_u32 s67, s71, 1
    v_add_u32 v98, s34, v92
    v_add_u32 v99, s34, v93
    v_mov_b32 v97, s67
    s_cmp_gt_u32 s33, s71
    s_cbranch_scc1 L_ldv_d
L_ldv:
    ds_read_b32 v100, v7 offset:0
    s_waitcnt lgkmcnt(0)
    v_readfirstlane_b32 s33, v100
    s_cmp_gt_u32 s33, s71
    s_cbranch_scc1 L_ldv_d
    s_sub_u32 s62, s62, 1
    s_cselect_b32 s62, 0, s62
    s_cbranch_scc0 L_ldv
L_ldv_d:
    ds_read_b64_tr_b16 v[16:17], v98 offset:0
    ds_read_b64_tr_b16 v[18:19], v98 offset:512
    ds_read_b64_tr_b16 v[20:21], v99 offset:0
    ds_read_b64_tr_b16 v[22:23], v99 offset:512
    ds_read_b64_tr_b16 v[24:25], v98 offset:1024
    ds_read_b64_tr_b16 v[26:27], v98 offset:1536
    ds_read_b64_tr_b16 v[28:29], v99 offset:1024
    ds_read_b64_tr_b16 v[30:31], v99 offset:1536
    ds_read_b64_tr_b16 v[32:33], v98 offset:2048
    ds_read_b64_tr_b16 v[34:35], v98 offset:2560
    ds_read_b64_tr_b16 v[36:37], v99 offset:2048
    ds_read_b64_tr_b16 v[38:39], v99 offset:2560
    s_waitcnt lgkmcnt(10)
    v_mfma_f32_16x16x32_bf16 v[64:67], v[12:15], v[16:19], v[64:67]
    s_waitcnt lgkmcnt(8)
    v_mfma_f32_16x16x32_bf16 v[68:71], v[12:15], v[20:23], v[68:71]
    s_waitcnt lgkmcnt(6)
    v_mfma_f32_16x16x32_bf16 v[72:75], v[12:15], v[24:27], v[72:75]
    s_waitcnt lgkmcnt(4)
    v_mfma_f32_16x16x32_bf16 v[76:79], v[12:15], v[28:31], v[76:79]
    s_waitcnt lgkmcnt(2)
    v_mfma_f32_16x16x32_bf16 v[80:83], v[12:15], v[32:35], v[80:83]
    s_waitcnt lgkmcnt(0)
    ds_write_b32 v96, v97 offset:16
    v_mfma_f32_16x16x32_bf16 v[84:87], v[12:15], v[36:39], v[84:87]
    s_add_u32 s71, s71, 1
    s_and_b32 s67, s71, 31
    s_cbranch_scc1 L_vtile
    v_cvt_pk_bf16_f32 v8, v64, v68
    v_cvt_pk_bf16_f32 v9, v72, v76
    s_nop 2
    v_cvt_pk_bf16_f32 v10, v80, v84
    v_cndmask_b32 v8, v8, v9, s[36:37]
    v_cndmask_b32 v8, v8, v10, s[38:39]
    v_min_u32 v8, -2, v8
    s_mov_b32 exec_hi, 0xffff
    s_cmp_lg_u32 s54, 2
    s_cbranch_scc1 L_ls1a
    buffer_store_dword v8, v95, s[56:59], s35 offen
    s_branch L_ls1b
L_ls1a:
    buffer_store_dword v8, v95, s[56:59], s35 offen sc1
L_ls1b:
    s_cmp_eq_u32 s72, 3
    s_cbranch_scc1 L_vend
    s_mov_b64 exec, 1
    s_waitcnt vmcnt(0)
    s_cmp_lg_u32 s54, 2
    s_cbranch_scc1 L_ls2a
    buffer_store_dword v101, off, s[56:59], s40
    s_branch L_ls2b
L_ls2a:
    buffer_store_dword v101, off, s[56:59], s40 sc1
L_ls2b:
    s_mov_b64 exec, -1
    s_add_u32 s35, s35, 98304
    s_add_u32 s40, s40, 2048
    s_add_u32 s72, s72, 1
    s_branch L_vgrp
L_vend:
    s_endpgm
L_rs:
    v_permlane32_swap_b32 v8, v12
    v_permlane32_swap_b32 v9, v13
    v_permlane32_swap_b32 v10, v14
    v_permlane32_swap_b32 v11, v15
    v_permlane32_swap_b32 v16, v20
    v_permlane32_swap_b32 v17, v21
    v_permlane32_swap_b32 v18, v22
    v_permlane32_swap_b32 v19, v23
    v_permlane32_swap_b32 v24, v28
    v_permlane32_swap_b32 v25, v29
    v_permlane32_swap_b32 v26, v30
    v_permlane32_swap_b32 v27, v31
    v_add_f32 v8, v8, v12
    v_add_f32 v9, v9, v13
    v_add_f32 v10, v10, v14
    v_add_f32 v11, v11, v15
    v_add_f32 v16, v16, v20
    v_add_f32 v17, v17, v21
    v_add_f32 v18, v18, v22
    v_add_f32 v19, v19, v23
    v_add_f32 v24, v24, v28
    v_add_f32 v25, v25, v29
    v_add_f32 v26, v26, v30
    v_add_f32 v27, v27, v31
    v_permlane16_swap_b32 v8, v10
    v_permlane16_swap_b32 v9, v11
    v_permlane16_swap_b32 v16, v18
    v_permlane16_swap_b32 v17, v19
    v_permlane16_swap_b32 v24, v26
    v_permlane16_swap_b32 v25, v27
    v_add_f32 v8, v8, v10
    v_add_f32 v9, v9, v11
    v_add_f32 v16, v16, v18
    v_add_f32 v17, v17, v19
    v_add_f32 v24, v24, v26
    v_add_f32 v25, v25, v27
    v_add_f32_dpp v8, v8, v8 row_ror:8 row_mask:0xf bank_mask:0x3
    v_add_f32_dpp v16, v16, v16 row_ror:8 row_mask:0xf bank_mask:0x3
    v_add_f32_dpp v24, v24, v24 row_ror:8 row_mask:0xf bank_mask:0x3
    v_add_f32_dpp v8, v9, v9 row_ror:8 row_mask:0xf bank_mask:0xc
    v_add_f32_dpp v16, v17, v17 row_ror:8 row_mask:0xf bank_mask:0xc
    v_add_f32_dpp v24, v25, v25 row_ror:8 row_mask:0xf bank_mask:0xc
    s_setpc_b64 s[64:65]
L_helper:
    v_lshlrev_b32 v5, 4, v1
    v_lshlrev_b32 v6, 2, v1
    v_lshl_add_u32 v60, v4, 3, v3
    v_lshlrev_b32 v60, 1, v60
    v_mov_b32 v49, 0xffffff00
    s_mov_b32 s67, 1392640
    s_waitcnt lgkmcnt(0)
    s_mov_b32 s56, s26
    s_mov_b32 s57, s27
    s_mov_b32 s58, 1449984
    s_mov_b32 s59, 0x20000
    s_cmp_lg_u32 s3, 4
    s_cbranch_scc1 L_notq
    s_load_dword s74, s[26:27], s67
    v_mov_b32 v8, 0
    v_mov_b32 v9, 0
    v_mov_b32 v10, 0
    v_mov_b32 v11, 0
    v_mov_b32 v12, 0
    v_mov_b32 v13, 0
    v_mov_b32 v14, 0
    v_mov_b32 v15, 0
    v_mov_b32 v16, 0
    v_mov_b32 v17, 0
    v_mov_b32 v18, 0
    v_mov_b32 v19, 0
    v_mov_b32 v20, 0
    v_mov_b32 v21, 0
    v_mov_b32 v22, 0
    v_mov_b32 v23, 0
    v_mov_b32 v24, 0
    v_mov_b32 v25, 0
    v_mov_b32 v26, 0
    v_mov_b32 v27, 0
    v_mov_b32 v28, 0
    v_mov_b32 v29, 0
    v_mov_b32 v30, 0
    v_mov_b32 v31, 0
    s_waitcnt vmcnt(30)
    v_lshlrev_b32 v32, 16, v52
    v_and_b32 v33, 0xffff0000, v52
    v_lshlrev_b32 v34, 16, v53
    v_and_b32 v35, 0xffff0000, v53
    v_lshlrev_b32 v36, 16, v54
    v_and_b32 v37, 0xffff0000, v54
    v_lshlrev_b32 v38, 16, v55
    v_and_b32 v39, 0xffff0000, v55
    v_lshlrev_b32 v40, 16, v56
    v_and_b32 v41, 0xffff0000, v56
    v_add_f32 v57, v32, v33
    v_add_f32 v57, v57, v34
    v_add_f32 v57, v57, v35
    v_add_f32 v57, v57, v36
    v_add_f32 v57, v57, v37
    v_add_f32 v57, v57, v38
    v_add_f32 v57, v57, v39
    v_add_f32 v57, v57, v40
    v_add_f32 v57, v57, v41
    s_nop 1
    v_add_f32_dpp v57, v57, v57 quad_perm:[1,0,3,2] row_mask:0xf bank_mask:0xf
    s_nop 1
    v_add_f32_dpp v57, v57, v57 quad_perm:[2,3,0,1] row_mask:0xf bank_mask:0xf
    s_nop 1
    v_add_f32_dpp v57, v57, v57 row_half_mirror row_mask:0xf bank_mask:0xf
    s_nop 1
    v_add_f32_dpp v57, v57, v57 row_ror:8 row_mask:0xf bank_mask:0xf
    v_mov_b32 v58, v57
    s_nop 1
    v_permlane16_swap_b32 v57, v58
    v_add_f32 v57, v57, v58
    v_mov_b32 v58, v57
    s_nop 1
    v_permlane32_swap_b32 v57, v58
    v_add_f32 v57, v57, v58
    v_mul_f32 v57, 0x3acccccd, v57
    v_sub_f32 v59, v32, v57
    v_mul_f32 v50, v59, v59
    v_sub_f32 v59, v33, v57
    v_fmac_f32 v50, v59, v59
    v_sub_f32 v59, v34, v57
    v_fmac_f32 v50, v59, v59
    v_sub_f32 v59, v35, v57
    v_fmac_f32 v50, v59, v59
    v_sub_f32 v59, v36, v57
    v_fmac_f32 v50, v59, v59
    v_sub_f32 v59, v37, v57
    v_fmac_f32 v50, v59, v59
    v_sub_f32 v59, v38, v57
    v_fmac_f32 v50, v59, v59
    v_sub_f32 v59, v39, v57
    v_fmac_f32 v50, v59, v59
    v_sub_f32 v59, v40, v57
    v_fmac_f32 v50, v59, v59
    v_sub_f32 v59, v41, v57
    v_fmac_f32 v50, v59, v59
    s_nop 1
    v_add_f32_dpp v50, v50, v50 quad_perm:[1,0,3,2] row_mask:0xf bank_mask:0xf
    s_nop 1
    v_add_f32_dpp v50, v50, v50 quad_perm:[2,3,0,1] row_mask:0xf bank_mask:0xf
    s_nop 1
    v_add_f32_dpp v50, v50, v50 row_half_mirror row_mask:0xf bank_mask:0xf
    s_nop 1
    v_add_f32_dpp v50, v50, v50 row_ror:8 row_mask:0xf bank_mask:0xf
    v_mov_b32 v58, v50
    s_nop 1
    v_permlane16_swap_b32 v50, v58
    v_add_f32 v50, v50, v58
    v_mov_b32 v58, v50
    s_nop 1
    v_permlane32_swap_b32 v50, v58
    v_add_f32 v50, v50, v58
    v_mul_f32 v50, 0x3acccccd, v50
    v_cvt_pk_bf16_f32 v58, v57, v50
    v_lshlrev_b32 v57, 16, v58
    v_and_b32 v50, 0xffff0000, v58
    v_add_f32 v50, 0x3727c5ac, v50
    v_cvt_pk_bf16_f32 v50, v50, v50
    v_and_b32 v50, 0xffff0000, v50
    v_sqrt_f32 v50, v50
    s_nop 0
    v_cvt_pk_bf16_f32 v50, v50, v50
    v_and_b32 v50, 0xffff0000, v50
    v_rcp_f32 v51, v50
    v_sub_f32 v32, v32, v57
    v_sub_f32 v33, v33, v57
    v_cvt_pk_bf16_f32 v58, v32, v33
    v_lshlrev_b32 v32, 16, v58
    v_and_b32 v33, 0xffff0000, v58
    v_mul_f32 v58, v32, v51
    v_mul_f32 v59, v33, v51
    v_fma_f32 v32, -v58, v50, v32
    v_fma_f32 v33, -v59, v50, v33
    v_fmac_f32 v58, v32, v51
    v_fmac_f32 v59, v33, v51
    v_cvt_pk_bf16_f32 v52, v58, v59
    v_sub_f32 v34, v34, v57
    v_sub_f32 v35, v35, v57
    v_cvt_pk_bf16_f32 v58, v34, v35
    v_lshlrev_b32 v34, 16, v58
    v_and_b32 v35, 0xffff0000, v58
    v_mul_f32 v58, v34, v51
    v_mul_f32 v59, v35, v51
    v_fma_f32 v34, -v58, v50, v34
    v_fma_f32 v35, -v59, v50, v35
    v_fmac_f32 v58, v34, v51
    v_fmac_f32 v59, v35, v51
    v_cvt_pk_bf16_f32 v53, v58, v59
    v_sub_f32 v36, v36, v57
    v_sub_f32 v37, v37, v57
    v_cvt_pk_bf16_f32 v58, v36, v37
    v_lshlrev_b32 v36, 16, v58
    v_and_b32 v37, 0xffff0000, v58
    v_mul_f32 v58, v36, v51
    v_mul_f32 v59, v37, v51
    v_fma_f32 v36, -v58, v50, v36
    v_fma_f32 v37, -v59, v50, v37
    v_fmac_f32 v58, v36, v51
    v_fmac_f32 v59, v37, v51
    v_cvt_pk_bf16_f32 v54, v58, v59
    v_sub_f32 v38, v38, v57
    v_sub_f32 v39, v39, v57
    v_cvt_pk_bf16_f32 v58, v38, v39
    v_lshlrev_b32 v38, 16, v58
    v_and_b32 v39, 0xffff0000, v58
    v_mul_f32 v58, v38, v51
    v_mul_f32 v59, v39, v51
    v_fma_f32 v38, -v58, v50, v38
    v_fma_f32 v39, -v59, v50, v39
    v_fmac_f32 v58, v38, v51
    v_fmac_f32 v59, v39, v51
    v_cvt_pk_bf16_f32 v55, v58, v59
    v_sub_f32 v40, v40, v57
    v_sub_f32 v41, v41, v57
    v_cvt_pk_bf16_f32 v58, v40, v41
    v_lshlrev_b32 v40, 16, v58
    v_and_b32 v41, 0xffff0000, v58
    v_mul_f32 v58, v40, v51
    v_mul_f32 v59, v41, v51
    v_fma_f32 v40, -v58, v50, v40
    v_fma_f32 v41, -v59, v50, v41
    v_fmac_f32 v58, v40, v51
    v_fmac_f32 v59, v41, v51
    v_cvt_pk_bf16_f32 v56, v58, v59
    v_add_u32 v58, 161792, v5
    v_add_u32 v59, 162816, v6
    ds_write_b128 v58, v[52:55]
    ds_write_b32 v59, v56
    s_waitcnt lgkmcnt(0)
    s_add_u32 s74, s74, 0x9e3779b1
    s_and_b32 s73, s74, 0xff
    v_mov_b32 v58, s74
    ds_write_b32 v7, v58 offset:28
    s_mul_i32 s67, s61, 160
    s_add_u32 s67, s67, 161792
    v_lshl_add_u32 v61, v3, 1, s67
    ds_read_u16 v32, v61 offset:0
    ds_read_u16 v33, v61 offset:16
    ds_read_u16 v34, v61 offset:32
    ds_read_u16 v35, v61 offset:48
    ds_read_u16 v36, v61 offset:64
    ds_read_u16 v37, v61 offset:80
    ds_read_u16 v38, v61 offset:96
    ds_read_u16 v39, v61 offset:112
    ds_read_u16 v40, v61 offset:128
    ds_read_u16 v41, v61 offset:144
    s_waitcnt lgkmcnt(0)
    v_lshlrev_b32 v52, 16, v32
    s_waitcnt vmcnt(27)
    v_dot2c_f32_bf16 v8, v64, v32
    v_dot2c_f32_bf16 v9, v64, v52
    v_dot2c_f32_bf16 v10, v65, v32
    v_dot2c_f32_bf16 v11, v65, v52
    v_dot2c_f32_bf16 v12, v66, v32
    v_dot2c_f32_bf16 v13, v66, v52
    v_dot2c_f32_bf16 v14, v67, v32
    v_dot2c_f32_bf16 v15, v67, v52
    v_dot2c_f32_bf16 v16, v68, v32
    v_dot2c_f32_bf16 v17, v68, v52
    v_dot2c_f32_bf16 v18, v69, v32
    v_dot2c_f32_bf16 v19, v69, v52
    v_dot2c_f32_bf16 v20, v70, v32
    v_dot2c_f32_bf16 v21, v70, v52
    v_dot2c_f32_bf16 v22, v71, v32
    v_dot2c_f32_bf16 v23, v71, v52
    v_dot2c_f32_bf16 v24, v72, v32
    v_dot2c_f32_bf16 v25, v72, v52
    v_dot2c_f32_bf16 v26, v73, v32
    v_dot2c_f32_bf16 v27, v73, v52
    v_dot2c_f32_bf16 v28, v74, v32
    v_dot2c_f32_bf16 v29, v74, v52
    v_dot2c_f32_bf16 v30, v75, v32
    v_dot2c_f32_bf16 v31, v75, v52
    v_lshlrev_b32 v52, 16, v33
    s_waitcnt vmcnt(24)
    v_dot2c_f32_bf16 v8, v76, v33
    v_dot2c_f32_bf16 v9, v76, v52
    v_dot2c_f32_bf16 v10, v77, v33
    v_dot2c_f32_bf16 v11, v77, v52
    v_dot2c_f32_bf16 v12, v78, v33
    v_dot2c_f32_bf16 v13, v78, v52
    v_dot2c_f32_bf16 v14, v79, v33
    v_dot2c_f32_bf16 v15, v79, v52
    v_dot2c_f32_bf16 v16, v80, v33
    v_dot2c_f32_bf16 v17, v80, v52
    v_dot2c_f32_bf16 v18, v81, v33
    v_dot2c_f32_bf16 v19, v81, v52
    v_dot2c_f32_bf16 v20, v82, v33
    v_dot2c_f32_bf16 v21, v82, v52
    v_dot2c_f32_bf16 v22, v83, v33
    v_dot2c_f32_bf16 v23, v83, v52
    v_dot2c_f32_bf16 v24, v84, v33
    v_dot2c_f32_bf16 v25, v84, v52
    v_dot2c_f32_bf16 v26, v85, v33
    v_dot2c_f32_bf16 v27, v85, v52
    v_dot2c_f32_bf16 v28, v86, v33
    v_dot2c_f32_bf16 v29, v86, v52
    v_dot2c_f32_bf16 v30, v87, v33
    v_dot2c_f32_bf16 v31, v87, v52
    v_lshlrev_b32 v52, 16, v34
    s_waitcnt vmcnt(21)
    v_dot2c_f32_bf16 v8, v88, v34
    v_dot2c_f32_bf16 v9, v88, v52
    v_dot2c_f32_bf16 v10, v89, v34
    v_dot2c_f32_bf16 v11, v89, v52
    v_dot2c_f32_bf16 v12, v90, v34
    v_dot2c_f32_bf16 v13, v90, v52
    v_dot2c_f32_bf16 v14, v91, v34
    v_dot2c_f32_bf16 v15, v91, v52
    v_dot2c_f32_bf16 v16, v92, v34
    v_dot2c_f32_bf16 v17, v92, v52
    v_dot2c_f32_bf16 v18, v93, v34
    v_dot2c_f32_bf16 v19, v93, v52
    v_dot2c_f32_bf16 v20, v94, v34
    v_dot2c_f32_bf16 v21, v94, v52
    v_dot2c_f32_bf16 v22, v95, v34
    v_dot2c_f32_bf16 v23, v95, v52
    v_dot2c_f32_bf16 v24, v96, v34
    v_dot2c_f32_bf16 v25, v96, v52
    v_dot2c_f32_bf16 v26, v97, v34
    v_dot2c_f32_bf16 v27, v97, v52
    v_dot2c_f32_bf16 v28, v98, v34
    v_dot2c_f32_bf16 v29, v98, v52
    v_dot2c_f32_bf16 v30, v99, v34
    v_dot2c_f32_bf16 v31, v99, v52
    v_lshlrev_b32 v52, 16, v35
    s_waitcnt vmcnt(18)
    v_dot2c_f32_bf16 v8, v100, v35
    v_dot2c_f32_bf16 v9, v100, v52
    v_dot2c_f32_bf16 v10, v101, v35
    v_dot2c_f32_bf16 v11, v101, v52
    v_dot2c_f32_bf16 v12, v102, v35
    v_dot2c_f32_bf16 v13, v102, v52
    v_dot2c_f32_bf16 v14, v103, v35
    v_dot2c_f32_bf16 v15, v103, v52
    v_dot2c_f32_bf16 v16, v104, v35
    v_dot2c_f32_bf16 v17, v104, v52
    v_dot2c_f32_bf16 v18, v105, v35
    v_dot2c_f32_bf16 v19, v105, v52
    v_dot2c_f32_bf16 v20, v106, v35
    v_dot2c_f32_bf16 v21, v106, v52
    v_dot2c_f32_bf16 v22, v107, v35
    v_dot2c_f32_bf16 v23, v107, v52
    v_dot2c_f32_bf16 v24, v108, v35
    v_dot2c_f32_bf16 v25, v108, v52
    v_dot2c_f32_bf16 v26, v109, v35
    v_dot2c_f32_bf16 v27, v109, v52
    v_dot2c_f32_bf16 v28, v110, v35
    v_dot2c_f32_bf16 v29, v110, v52
    v_dot2c_f32_bf16 v30, v111, v35
    v_dot2c_f32_bf16 v31, v111, v52
    v_lshlrev_b32 v52, 16, v36
    s_waitcnt vmcnt(15)
    v_dot2c_f32_bf16 v8, v112, v36
    v_dot2c_f32_bf16 v9, v112, v52
    v_dot2c_f32_bf16 v10, v113, v36
    v_dot2c_f32_bf16 v11, v113, v52
    v_dot2c_f32_bf16 v12, v114, v36
    v_dot2c_f32_bf16 v13, v114, v52
    v_dot2c_f32_bf16 v14, v115, v36
    v_dot2c_f32_bf16 v15, v115, v52
    v_dot2c_f32_bf16 v16, v116, v36
    v_dot2c_f32_bf16 v17, v116, v52
    v_dot2c_f32_bf16 v18, v117, v36
    v_dot2c_f32_bf16 v19, v117, v52
    v_dot2c_f32_bf16 v20, v118, v36
    v_dot2c_f32_bf16 v21, v118, v52
    v_dot2c_f32_bf16 v22, v119, v36
    v_dot2c_f32_bf16 v23, v119, v52
    v_dot2c_f32_bf16 v24, v120, v36
    v_dot2c_f32_bf16 v25, v120, v52
    v_dot2c_f32_bf16 v26, v121, v36
    v_dot2c_f32_bf16 v27, v121, v52
    v_dot2c_f32_bf16 v28, v122, v36
    v_dot2c_f32_bf16 v29, v122, v52
    v_dot2c_f32_bf16 v30, v123, v36
    v_dot2c_f32_bf16 v31, v123, v52
    v_lshlrev_b32 v52, 16, v37
    s_waitcnt vmcnt(12)
    v_dot2c_f32_bf16 v8, v124, v37
    v_dot2c_f32_bf16 v9, v124, v52
    v_dot2c_f32_bf16 v10, v125, v37
    v_dot2c_f32_bf16 v11, v125, v52
    v_dot2c_f32_bf16 v12, v126, v37
    v_dot2c_f32_bf16 v13, v126, v52
    v_dot2c_f32_bf16 v14, v127, v37
    v_dot2c_f32_bf16 v15, v127, v52
    v_dot2c_f32_bf16 v16, v128, v37
    v_dot2c_f32_bf16 v17, v128, v52
    v_dot2c_f32_bf16 v18, v129, v37
    v_dot2c_f32_bf16 v19, v129, v52
    v_dot2c_f32_bf16 v20, v130, v37
    v_dot2c_f32_bf16 v21, v130, v52
    v_dot2c_f32_bf16 v22, v131, v37
    v_dot2c_f32_bf16 v23, v131, v52
    v_dot2c_f32_bf16 v24, v132, v37
    v_dot2c_f32_bf16 v25, v132, v52
    v_dot2c_f32_bf16 v26, v133, v37
    v_dot2c_f32_bf16 v27, v133, v52
    v_dot2c_f32_bf16 v28, v134, v37
    v_dot2c_f32_bf16 v29, v134, v52
    v_dot2c_f32_bf16 v30, v135, v37
    v_dot2c_f32_bf16 v31, v135, v52
    v_lshlrev_b32 v52, 16, v38
    s_waitcnt vmcnt(9)
    v_dot2c_f32_bf16 v8, v136, v38
    v_dot2c_f32_bf16 v9, v136, v52
    v_dot2c_f32_bf16 v10, v137, v38
    v_dot2c_f32_bf16 v11, v137, v52
    v_dot2c_f32_bf16 v12, v138, v38
    v_dot2c_f32_bf16 v13, v138, v52
    v_dot2c_f32_bf16 v14, v139, v38
    v_dot2c_f32_bf16 v15, v139, v52
    v_dot2c_f32_bf16 v16, v140, v38
    v_dot2c_f32_bf16 v17, v140, v52
    v_dot2c_f32_bf16 v18, v141, v38
    v_dot2c_f32_bf16 v19, v141, v52
    v_dot2c_f32_bf16 v20, v142, v38
    v_dot2c_f32_bf16 v21, v142, v52
    v_dot2c_f32_bf16 v22, v143, v38
    v_dot2c_f32_bf16 v23, v143, v52
    v_dot2c_f32_bf16 v24, v144, v38
    v_dot2c_f32_bf16 v25, v144, v52
    v_dot2c_f32_bf16 v26, v145, v38
    v_dot2c_f32_bf16 v27, v145, v52
    v_dot2c_f32_bf16 v28, v146, v38
    v_dot2c_f32_bf16 v29, v146, v52
    v_dot2c_f32_bf16 v30, v147, v38
    v_dot2c_f32_bf16 v31, v147, v52
    v_lshlrev_b32 v52, 16, v39
    s_waitcnt vmcnt(6)
    v_dot2c_f32_bf16 v8, v148, v39
    v_dot2c_f32_bf16 v9, v148, v52
    v_dot2c_f32_bf16 v10, v149, v39
    v_dot2c_f32_bf16 v11, v149, v52
    v_dot2c_f32_bf16 v12, v150, v39
    v_dot2c_f32_bf16 v13, v150, v52
    v_dot2c_f32_bf16 v14, v151, v39
    v_dot2c_f32_bf16 v15, v151, v52
    v_dot2c_f32_bf16 v16, v152, v39
    v_dot2c_f32_bf16 v17, v152, v52
    v_dot2c_f32_bf16 v18, v153, v39
    v_dot2c_f32_bf16 v19, v153, v52
    v_dot2c_f32_bf16 v20, v154, v39
    v_dot2c_f32_bf16 v21, v154, v52
    v_dot2c_f32_bf16 v22, v155, v39
    v_dot2c_f32_bf16 v23, v155, v52
    v_dot2c_f32_bf16 v24, v156, v39
    v_dot2c_f32_bf16 v25, v156, v52
    v_dot2c_f32_bf16 v26, v157, v39
    v_dot2c_f32_bf16 v27, v157, v52
    v_dot2c_f32_bf16 v28, v158, v39
    v_dot2c_f32_bf16 v29, v158, v52
    v_dot2c_f32_bf16 v30, v159, v39
    v_dot2c_f32_bf16 v31, v159, v52
    v_lshlrev_b32 v52, 16, v40
    s_waitcnt vmcnt(3)
    v_dot2c_f32_bf16 v8, v160, v40
    v_dot2c_f32_bf16 v9, v160, v52
    v_dot2c_f32_bf16 v10, v161, v40
    v_dot2c_f32_bf16 v11, v161, v52
    v_dot2c_f32_bf16 v12, v162, v40
    v_dot2c_f32_bf16 v13, v162, v52
    v_dot2c_f32_bf16 v14, v163, v40
    v_dot2c_f32_bf16 v15, v163, v52
    v_dot2c_f32_bf16 v16, v164, v40
    v_dot2c_f32_bf16 v17, v164, v52
    v_dot2c_f32_bf16 v18, v165, v40
    v_dot2c_f32_bf16 v19, v165, v52
    v_dot2c_f32_bf16 v20, v166, v40
    v_dot2c_f32_bf16 v21, v166, v52
    v_dot2c_f32_bf16 v22, v167, v40
    v_dot2c_f32_bf16 v23, v167, v52
    v_dot2c_f32_bf16 v24, v168, v40
    v_dot2c_f32_bf16 v25, v168, v52
    v_dot2c_f32_bf16 v26, v169, v40
    v_dot2c_f32_bf16 v27, v169, v52
    v_dot2c_f32_bf16 v28, v170, v40
    v_dot2c_f32_bf16 v29, v170, v52
    v_dot2c_f32_bf16 v30, v171, v40
    v_dot2c_f32_bf16 v31, v171, v52
    v_lshlrev_b32 v52, 16, v41
    s_waitcnt vmcnt(0)
    v_dot2c_f32_bf16 v8, v172, v41
    v_dot2c_f32_bf16 v9, v172, v52
    v_dot2c_f32_bf16 v10, v173, v41
    v_dot2c_f32_bf16 v11, v173, v52
    v_dot2c_f32_bf16 v12, v174, v41
    v_dot2c_f32_bf16 v13, v174, v52
    v_dot2c_f32_bf16 v14, v175, v41
    v_dot2c_f32_bf16 v15, v175, v52
    v_dot2c_f32_bf16 v16, v176, v41
    v_dot2c_f32_bf16 v17, v176, v52
    v_dot2c_f32_bf16 v18, v177, v41
    v_dot2c_f32_bf16 v19, v177, v52
    v_dot2c_f32_bf16 v20, v178, v41
    v_dot2c_f32_bf16 v21, v178, v52
    v_dot2c_f32_bf16 v22, v179, v41
    v_dot2c_f32_bf16 v23, v179, v52
    v_dot2c_f32_bf16 v24, v180, v41
    v_dot2c_f32_bf16 v25, v180, v52
    v_dot2c_f32_bf16 v26, v181, v41
    v_dot2c_f32_bf16 v27, v181, v52
    v_dot2c_f32_bf16 v28, v182, v41
    v_dot2c_f32_bf16 v29, v182, v52
    v_dot2c_f32_bf16 v30, v183, v41
    v_dot2c_f32_bf16 v31, v183, v52
    s_call_b64 s[64:65], L_rs
    s_getreg_b32 s53, hwreg(HW_REG_XCC_ID, 0, 4)
    s_xor_b32 s53, s53, s74
    v_mov_b32 v9, v16
    v_mov_b32 v10, v24
    v_mov_b32 v11, s53
    v_lshlrev_b32 v5, 4, v1
    s_lshl_b32 s67, s60, 13
    s_lshl_b32 s68, s61, 10
    s_add_u32 s68, s68, s67
    s_add_u32 s68, s68, 851968
    s_mov_b32 s52, s68
    s_mov_b32 s55, 12
    buffer_store_dwordx4 v[8:11], v5, s[56:59], s68 offen
    s_lshl_b32 s67, s63, 13
    s_add_u32 s67, s67, 851968
    v_add_u32 v59, 160256, v60
    s_mov_b32 s72, 0
L_qg:
    s_add_u32 s68, s67, 4096
L_xq_p:
    buffer_load_dwordx4 v[64:67], v5, s[56:59], s67 offen offset:0 sc1
    buffer_load_dwordx4 v[68:71], v5, s[56:59], s67 offen offset:1024 sc1
    buffer_load_dwordx4 v[72:75], v5, s[56:59], s67 offen offset:2048 sc1
    buffer_load_dwordx4 v[76:79], v5, s[56:59], s67 offen offset:3072 sc1
    buffer_load_dwordx4 v[80:83], v5, s[56:59], s68 offen offset:0 sc1
    buffer_load_dwordx4 v[84:87], v5, s[56:59], s68 offen offset:1024 sc1
    buffer_load_dwordx4 v[88:91], v5, s[56:59], s68 offen offset:2048 sc1
    buffer_load_dwordx4 v[92:95], v5, s[56:59], s68 offen offset:3072 sc1
    s_waitcnt vmcnt(7)
    v_xor_b32 v6, s74, v67
    s_waitcnt vmcnt(6)
    v_xor_b32 v71, s74, v71
    v_or_b32 v6, v6, v71
    s_waitcnt vmcnt(5)
    v_xor_b32 v75, s74, v75
    v_or_b32 v6, v6, v75
    s_waitcnt vmcnt(4)
    v_xor_b32 v79, s74, v79
    v_or_b32 v6, v6, v79
    s_waitcnt vmcnt(3)
    v_xor_b32 v83, s74, v83
    v_or_b32 v6, v6, v83
    s_waitcnt vmcnt(2)
    v_xor_b32 v87, s74, v87
    v_or_b32 v6, v6, v87
    s_waitcnt vmcnt(1)
    v_xor_b32 v91, s74, v91
    v_or_b32 v6, v6, v91
    s_waitcnt vmcnt(0)
    v_xor_b32 v95, s74, v95
    v_or_b32 v6, v6, v95
    v_cmp_lt_u32 vcc, 15, v6
    s_cbranch_vccz L_xq_d
    s_sub_u32 s55, s55, 1
    s_max_i32 s55, s55, -1
    s_cmp_lg_u32 s55, 0
    s_cbranch_scc1 L_rp1
    buffer_store_dwordx4 v[8:11], v5, s[56:59], s52 offen sc1
L_rp1:
    s_sub_u32 s62, s62, 16
    s_cselect_b32 s62, 0, s62
    s_cbranch_scc0 L_xq_p
L_xq_d:
    v_add_f32 v64, v64, v68
    v_add_f32 v65, v65, v69
    v_add_f32 v66, v66, v70
    v_add_f32 v64, v64, v72
    v_add_f32 v65, v65, v73
    v_add_f32 v66, v66, v74
    v_add_f32 v64, v64, v76
    v_add_f32 v65, v65, v77
    v_add_f32 v66, v66, v78
    v_add_f32 v64, v64, v80
    v_add_f32 v65, v65, v81
    v_add_f32 v66, v66, v82
    v_add_f32 v64, v64, v84
    v_add_f32 v65, v65, v85
    v_add_f32 v66, v66, v86
    v_add_f32 v64, v64, v88
    v_add_f32 v65, v65, v89
    v_add_f32 v66, v66, v90
    v_add_f32 v64, v64, v92
    v_add_f32 v65, v65, v93
    v_add_f32 v66, v66, v94
    s_add_u32 s72, s72, 1
    v_cvt_pk_bf16_f32 v64, v64, v65
    v_cvt_pk_bf16_f32 v66, v66, v66
    v_mov_b32 v58, s72
    ds_write_b16 v59, v64
    ds_write_b16_d16_hi v59, v64 offset:128
    ds_write_b16 v59, v66 offset:256
    ds_write_b32 v7, v58 offset:4
    v_add_u32 v59, 384, v59
    s_setprio 0
    s_add_u32 s67, s67, 65536
    s_cmp_ge_u32 s72, 4
    s_cbranch_scc1 L_t2
    s_cmp_lg_u32 s72, 1
    s_cbranch_scc1 L_noclr
L_cw:
    ds_read_b64 v[62:63], v7 offset:16
    s_waitcnt lgkmcnt(0)
    v_min_u32 v62, v62, v63
    s_nop 0
    v_readfirstlane_b32 s70, v62
    s_cmp_gt_u32 s70, 8
    s_cbranch_scc1 L_cw_d
    s_sleep 8
    s_sub_u32 s62, s62, 9
    s_cselect_b32 s62, 0, s62
    s_cbranch_scc0 L_cw
L_cw_d:
    v_and_b32 v57, 3, v3
    v_lshlrev_b32 v57, 16, v57
    v_lshl_add_u32 v57, v4, 10, v57
    s_sub_u32 s69, s67, 65536
L_lp:
    buffer_load_dword v48, v57, s[56:59], s69 offen offset:12 sc1
    s_waitcnt vmcnt(0)
    v_xor_b32 v58, s74, v48
    v_cmp_lt_u32 vcc, 15, v58
    s_cbranch_vccz L_lq
    s_sub_u32 s55, s55, 1
    s_max_i32 s55, s55, -1
    s_cmp_lg_u32 s55, 0
    s_cbranch_scc1 L_rp2
    buffer_store_dwordx4 v[8:11], v5, s[56:59], s52 offen sc1
L_rp2:
    s_sleep 16
    s_sub_u32 s62, s62, 32
    s_cselect_b32 s62, 0, s62
    s_cbranch_scc0 L_lp
L_lq:
    v_cmp_ne_u32 vcc, s53, v48
    s_cmp_eq_u64 vcc, 0
    s_cselect_b32 s54, 2, 1
    v_mov_b32 v48, s54
    ds_write_b32 v7, v48 offset:12
    s_cbranch_scc1 L_noclr
    s_cmp_lt_i32 s55, 1
    s_cbranch_scc1 L_rp3
    s_mov_b32 s55, 0
    buffer_store_dwordx4 v[8:11], v5, s[56:59], s52 offen sc1
L_rp3:
L_noclr:
    s_lshl_b32 s71, s72, 5
    s_sub_u32 s71, s71, 16
L_qd:
    ds_read_b64 v[62:63], v7 offset:16
    s_waitcnt lgkmcnt(0)
    v_min_u32 v62, v62, v63
    s_nop 0
    v_readfirstlane_b32 s70, v62
    s_cmp_gt_u32 s70, s71
    s_cbranch_scc1 L_qd_d
    s_sleep 16
    s_sub_u32 s62, s62, 17
    s_cselect_b32 s62, 0, s62
    s_cbranch_scc0 L_qd
L_qd_d:
    s_branch L_qg
L_notq:
    s_cmp_lg_u32 s3, 7
    s_cbranch_scc1 L_notouch
    s_mov_b64 exec, 1
    s_mov_b32 s47, 0x20000
    s_mul_i32 s67, s63, 12582912
    s_mul_i32 s68, s66, 12288
    s_add_u32 s67, s67, s68
    s_mov_b32 s44, s6
    s_mov_b32 s45, s7
    s_mov_b32 s46, 402653184
    buffer_load_dword v8, off, s[44:47], s67
    s_mul_i32 s67, s60, 245760
    s_mov_b32 s44, s12
    s_mov_b32 s45, s13
    s_mov_b32 s46, 7864320
    buffer_load_dword v9, off, s[44:47], s67
    s_mul_i32 s67, s75, 61440
    s_mov_b32 s44, s20
    s_mov_b32 s45, s21
    s_mov_b32 s46, 1966080
    buffer_load_dword v10, off, s[44:47], s67
    s_mov_b64 exec, 0xff
    v_lshlrev_b32 v11, 7, v1
    s_lshl_b32 s67, s60, 13
    s_lshl_b32 s68, s61, 10
    s_add_u32 s67, s67, s68
    s_add_u32 s67, s67, 851968
    buffer_load_dword v12, v11, s[56:59], s67 offen
    s_mov_b64 exec, 7
    s_mul_i32 s67, s60, 3072
    s_mul_i32 s68, s61, 384
    s_add_u32 s67, s67, s68
    s_add_u32 s67, s67, 1114112
    buffer_load_dword v13, v11, s[56:59], s67 offen
    s_mul_i32 s67, s63, 12288
    s_mul_i32 s68, s66, 384
    s_add_u32 s67, s67, s68
    buffer_load_dword v14, v11, s[56:59], s67 offen
    s_add_u32 s67, s67, 98304
    buffer_load_dword v15, v11, s[56:59], s67 offen
    s_add_u32 s67, s67, 98304
    buffer_load_dword v16, v11, s[56:59], s67 offen
    s_add_u32 s67, s67, 98304
    v_lshlrev_b32 v11, 11, v1
    s_lshl_b32 s67, s63, 8
    s_lshl_b32 s68, s66, 3
    s_add_u32 s67, s67, s68
    s_add_u32 s67, s67, 1441792
    buffer_load_dword v17, v11, s[56:59], s67 offen
    s_mov_b64 exec, 3
    v_lshlrev_b32 v11, 10, v1
    s_lshl_b32 s67, s63, 11
    s_lshl_b32 s68, s66, 5
    s_add_u32 s67, s67, s68
    s_add_u32 s67, s67, 1376256
    buffer_load_dword v18, v11, s[56:59], s67 offen
    s_mov_b64 exec, -1
L_notouch:
    s_cmp_eq_u32 s3, 3
    s_cbranch_scc1 L_fb
    s_cmp_eq_u32 s3, 6
    s_cbranch_scc1 L_stats
    s_cmp_eq_u32 s3, 7
    s_cbranch_scc1 L_t2
L_fw:
    ds_read_b64 v[62:63], v7 offset:16
    s_waitcnt lgkmcnt(0)
    v_min_u32 v62, v62, v63
    s_nop 0
    v_readfirstlane_b32 s70, v62
    s_cmp_gt_u32 s70, 0
    s_cbranch_scc1 L_fw_d
    s_sleep 8
    s_sub_u32 s62, s62, 9
    s_cselect_b32 s62, 0, s62
    s_cbranch_scc0 L_fw
L_fw_d:
    ds_read_b32 v62, v7 offset:28
    s_waitcnt lgkmcnt(0)
    v_readfirstlane_b32 s74, v62
    s_and_b32 s73, s74, 0xff
L_fl:
    ds_read_b32 v62, v7 offset:12
    s_waitcnt lgkmcnt(0)
    v_readfirstlane_b32 s54, v62
    s_cmp_gt_u32 s54, 0
    s_cbranch_scc1 L_fl_d
    s_sleep 8
    s_sub_u32 s62, s62, 9
    s_cselect_b32 s62, 0, s62
    s_cbranch_scc0 L_fl
L_fl_d:
    s_mul_i32 s67, s61, 160
    s_add_u32 s67, s67, 161792
    v_lshl_add_u32 v61, v3, 1, s67
    ds_read_u16 v32, v61 offset:0
    ds_read_u16 v33, v61 offset:16
    ds_read_u16 v34, v61 offset:32
    ds_read_u16 v35, v61 offset:48
    ds_read_u16 v36, v61 offset:64
    ds_read_u16 v37, v61 offset:80
    ds_read_u16 v38, v61 offset:96
    ds_read_u16 v39, v61 offset:112
    ds_read_u16 v40, v61 offset:128
    ds_read_u16 v41, v61 offset:144
    v_mul_u32_u24 v2, 96, v3
    v_lshl_add_u32 v2, v4, 4, v2
    v_add_u32 v2, 136704, v2
    v_mov_b32 v8, 0
    v_mov_b32 v9, 0
    v_mov_b32 v10, 0
    v_mov_b32 v11, 0
    v_mov_b32 v12, 0
    v_mov_b32 v13, 0
    v_mov_b32 v14, 0
    v_mov_b32 v15, 0
    v_mov_b32 v16, 0
    v_mov_b32 v17, 0
    v_mov_b32 v18, 0
    v_mov_b32 v19, 0
    v_mov_b32 v20, 0
    v_mov_b32 v21, 0
    v_mov_b32 v22, 0
    v_mov_b32 v23, 0
    v_mov_b32 v24, 0
    v_mov_b32 v25, 0
    v_mov_b32 v26, 0
    v_mov_b32 v27, 0
    v_mov_b32 v28, 0
    v_mov_b32 v29, 0
    v_mov_b32 v30, 0
    v_mov_b32 v31, 0
    s_waitcnt lgkmcnt(0)
    ds_read_b128 v[64:67], v2 offset:0
    ds_read_b128 v[68:71], v2 offset:7680
    ds_read_b128 v[72:75], v2 offset:768
    ds_read_b128 v[76:79], v2 offset:8448
    ds_read_b128 v[80:83], v2 offset:1536
    ds_read_b128 v[84:87], v2 offset:9216
    ds_read_b128 v[88:91], v2 offset:2304
    ds_read_b128 v[92:95], v2 offset:9984
    ds_read_b128 v[96:99], v2 offset:3072
    ds_read_b128 v[100:103], v2 offset:10752
    s_waitcnt lgkmcnt(0)
    v_lshlrev_b32 v52, 16, v32
    v_dot2c_f32_bf16 v8, v64, v32
    v_dot2c_f32_bf16 v9, v64, v52
    v_dot2c_f32_bf16 v10, v65, v32
    v_dot2c_f32_bf16 v11, v65, v52
    v_dot2c_f32_bf16 v12, v66, v32
    v_dot2c_f32_bf16 v13, v66, v52
    v_dot2c_f32_bf16 v14, v67, v32
    v_dot2c_f32_bf16 v15, v67, v52
    v_dot2c_f32_bf16 v16, v68, v32
    v_dot2c_f32_bf16 v17, v68, v52
    v_dot2c_f32_bf16 v18, v69, v32
    v_dot2c_f32_bf16 v19, v69, v52
    v_dot2c_f32_bf16 v20, v70, v32
    v_dot2c_f32_bf16 v21, v70, v52
    v_dot2c_f32_bf16 v22, v71, v32
    v_dot2c_f32_bf16 v23, v71, v52
    v_lshlrev_b32 v52, 16, v33
    v_dot2c_f32_bf16 v8, v72, v33
    v_dot2c_f32_bf16 v9, v72, v52
    v_dot2c_f32_bf16 v10, v73, v33
    v_dot2c_f32_bf16 v11, v73, v52
    v_dot2c_f32_bf16 v12, v74, v33
    v_dot2c_f32_bf16 v13, v74, v52
    v_dot2c_f32_bf16 v14, v75, v33
    v_dot2c_f32_bf16 v15, v75, v52
    v_dot2c_f32_bf16 v16, v76, v33
    v_dot2c_f32_bf16 v17, v76, v52
    v_dot2c_f32_bf16 v18, v77, v33
    v_dot2c_f32_bf16 v19, v77, v52
    v_dot2c_f32_bf16 v20, v78, v33
    v_dot2c_f32_bf16 v21, v78, v52
    v_dot2c_f32_bf16 v22, v79, v33
    v_dot2c_f32_bf16 v23, v79, v52
    v_lshlrev_b32 v52, 16, v34
    v_dot2c_f32_bf16 v8, v80, v34
    v_dot2c_f32_bf16 v9, v80, v52
    v_dot2c_f32_bf16 v10, v81, v34
    v_dot2c_f32_bf16 v11, v81, v52
    v_dot2c_f32_bf16 v12, v82, v34
    v_dot2c_f32_bf16 v13, v82, v52
    v_dot2c_f32_bf16 v14, v83, v34
    v_dot2c_f32_bf16 v15, v83, v52
    v_dot2c_f32_bf16 v16, v84, v34
    v_dot2c_f32_bf16 v17, v84, v52
    v_dot2c_f32_bf16 v18, v85, v34
    v_dot2c_f32_bf16 v19, v85, v52
    v_dot2c_f32_bf16 v20, v86, v34
    v_dot2c_f32_bf16 v21, v86, v52
    v_dot2c_f32_bf16 v22, v87, v34
    v_dot2c_f32_bf16 v23, v87, v52
    v_lshlrev_b32 v52, 16, v35
    v_dot2c_f32_bf16 v8, v88, v35
    v_dot2c_f32_bf16 v9, v88, v52
    v_dot2c_f32_bf16 v10, v89, v35
    v_dot2c_f32_bf16 v11, v89, v52
    v_dot2c_f32_bf16 v12, v90, v35
    v_dot2c_f32_bf16 v13, v90, v52
    v_dot2c_f32_bf16 v14, v91, v35
    v_dot2c_f32_bf16 v15, v91, v52
    v_dot2c_f32_bf16 v16, v92, v35
    v_dot2c_f32_bf16 v17, v92, v52
    v_dot2c_f32_bf16 v18, v93, v35
    v_dot2c_f32_bf16 v19, v93, v52
    v_dot2c_f32_bf16 v20, v94, v35
    v_dot2c_f32_bf16 v21, v94, v52
    v_dot2c_f32_bf16 v22, v95, v35
    v_dot2c_f32_bf16 v23, v95, v52
    v_lshlrev_b32 v52, 16, v36
    v_dot2c_f32_bf16 v8, v96, v36
    v_dot2c_f32_bf16 v9, v96, v52
    v_dot2c_f32_bf16 v10, v97, v36
    v_dot2c_f32_bf16 v11, v97, v52
    v_dot2c_f32_bf16 v12, v98, v36
    v_dot2c_f32_bf16 v13, v98, v52
    v_dot2c_f32_bf16 v14, v99, v36
    v_dot2c_f32_bf16 v15, v99, v52
    v_dot2c_f32_bf16 v16, v100, v36
    v_dot2c_f32_bf16 v17, v100, v52
    v_dot2c_f32_bf16 v18, v101, v36
    v_dot2c_f32_bf16 v19, v101, v52
    v_dot2c_f32_bf16 v20, v102, v36
    v_dot2c_f32_bf16 v21, v102, v52
    v_dot2c_f32_bf16 v22, v103, v36
    v_dot2c_f32_bf16 v23, v103, v52
    ds_read_b128 v[64:67], v2 offset:3840
    ds_read_b128 v[68:71], v2 offset:11520
    ds_read_b128 v[72:75], v2 offset:4608
    ds_read_b128 v[76:79], v2 offset:12288
    ds_read_b128 v[80:83], v2 offset:5376
    ds_read_b128 v[84:87], v2 offset:13056
    ds_read_b128 v[88:91], v2 offset:6144
    ds_read_b128 v[92:95], v2 offset:13824
    ds_read_b128 v[96:99], v2 offset:6912
    ds_read_b128 v[100:103], v2 offset:14592
    s_waitcnt lgkmcnt(0)
    v_lshlrev_b32 v52, 16, v37
    v_dot2c_f32_bf16 v8, v64, v37
    v_dot2c_f32_bf16 v9, v64, v52
    v_dot2c_f32_bf16 v10, v65, v37
    v_dot2c_f32_bf16 v11, v65, v52
    v_dot2c_f32_bf16 v12, v66, v37
    v_dot2c_f32_bf16 v13, v66, v52
    v_dot2c_f32_bf16 v14, v67, v37
    v_dot2c_f32_bf16 v15, v67, v52
    v_dot2c_f32_bf16 v16, v68, v37
    v_dot2c_f32_bf16 v17, v68, v52
    v_dot2c_f32_bf16 v18, v69, v37
    v_dot2c_f32_bf16 v19, v69, v52
    v_dot2c_f32_bf16 v20, v70, v37
    v_dot2c_f32_bf16 v21, v70, v52
    v_dot2c_f32_bf16 v22, v71, v37
    v_dot2c_f32_bf16 v23, v71, v52
    v_lshlrev_b32 v52, 16, v38
    v_dot2c_f32_bf16 v8, v72, v38
    v_dot2c_f32_bf16 v9, v72, v52
    v_dot2c_f32_bf16 v10, v73, v38
    v_dot2c_f32_bf16 v11, v73, v52
    v_dot2c_f32_bf16 v12, v74, v38
    v_dot2c_f32_bf16 v13, v74, v52
    v_dot2c_f32_bf16 v14, v75, v38
    v_dot2c_f32_bf16 v15, v75, v52
    v_dot2c_f32_bf16 v16, v76, v38
    v_dot2c_f32_bf16 v17, v76, v52
    v_dot2c_f32_bf16 v18, v77, v38
    v_dot2c_f32_bf16 v19, v77, v52
    v_dot2c_f32_bf16 v20, v78, v38
    v_dot2c_f32_bf16 v21, v78, v52
    v_dot2c_f32_bf16 v22, v79, v38
    v_dot2c_f32_bf16 v23, v79, v52
    v_lshlrev_b32 v52, 16, v39
    v_dot2c_f32_bf16 v8, v80, v39
    v_dot2c_f32_bf16 v9, v80, v52
    v_dot2c_f32_bf16 v10, v81, v39
    v_dot2c_f32_bf16 v11, v81, v52
    v_dot2c_f32_bf16 v12, v82, v39
    v_dot2c_f32_bf16 v13, v82, v52
    v_dot2c_f32_bf16 v14, v83, v39
    v_dot2c_f32_bf16 v15, v83, v52
    v_dot2c_f32_bf16 v16, v84, v39
    v_dot2c_f32_bf16 v17, v84, v52
    v_dot2c_f32_bf16 v18, v85, v39
    v_dot2c_f32_bf16 v19, v85, v52
    v_dot2c_f32_bf16 v20, v86, v39
    v_dot2c_f32_bf16 v21, v86, v52
    v_dot2c_f32_bf16 v22, v87, v39
    v_dot2c_f32_bf16 v23, v87, v52
    v_lshlrev_b32 v52, 16, v40
    v_dot2c_f32_bf16 v8, v88, v40
    v_dot2c_f32_bf16 v9, v88, v52
    v_dot2c_f32_bf16 v10, v89, v40
    v_dot2c_f32_bf16 v11, v89, v52
    v_dot2c_f32_bf16 v12, v90, v40
    v_dot2c_f32_bf16 v13, v90, v52
    v_dot2c_f32_bf16 v14, v91, v40
    v_dot2c_f32_bf16 v15, v91, v52
    v_dot2c_f32_bf16 v16, v92, v40
    v_dot2c_f32_bf16 v17, v92, v52
    v_dot2c_f32_bf16 v18, v93, v40
    v_dot2c_f32_bf16 v19, v93, v52
    v_dot2c_f32_bf16 v20, v94, v40
    v_dot2c_f32_bf16 v21, v94, v52
    v_dot2c_f32_bf16 v22, v95, v40
    v_dot2c_f32_bf16 v23, v95, v52
    v_lshlrev_b32 v52, 16, v41
    v_dot2c_f32_bf16 v8, v96, v41
    v_dot2c_f32_bf16 v9, v96, v52
    v_dot2c_f32_bf16 v10, v97, v41
    v_dot2c_f32_bf16 v11, v97, v52
    v_dot2c_f32_bf16 v12, v98, v41
    v_dot2c_f32_bf16 v13, v98, v52
    v_dot2c_f32_bf16 v14, v99, v41
    v_dot2c_f32_bf16 v15, v99, v52
    v_dot2c_f32_bf16 v16, v100, v41
    v_dot2c_f32_bf16 v17, v100, v52
    v_dot2c_f32_bf16 v18, v101, v41
    v_dot2c_f32_bf16 v19, v101, v52
    v_dot2c_f32_bf16 v20, v102, v41
    v_dot2c_f32_bf16 v21, v102, v52
    v_dot2c_f32_bf16 v22, v103, v41
    v_dot2c_f32_bf16 v23, v103, v52
    s_call_b64 s[64:65], L_rs
    v_mov_b32 v9, v16
    v_lshlrev_b32 v58, 2, v60
    s_mul_i32 s67, s60, 3072
    s_add_u32 s67, s67, 1114112
    s_mul_i32 s68, s61, 384
    s_add_u32 s68, s68, s67
    v_and_or_b32 v8, v8, v49, s73
    v_and_or_b32 v9, v9, v49, s73
    s_mov_b32 exec_lo, 0x3f3f3f3f
    s_mov_b32 exec_hi, 0x3f3f3f3f
    s_cmp_lg_u32 s54, 2
    s_cbranch_scc1 L_ls3a
    buffer_store_dwordx2 v[8:9], v58, s[56:59], s68 offen
    s_branch L_ls3b
L_ls3a:
    buffer_store_dwordx2 v[8:9], v58, s[56:59], s68 offen sc1
L_ls3b:
L_fw2:
    ds_read_b64 v[62:63], v7 offset:16
    s_waitcnt lgkmcnt(0)
    v_min_u32 v62, v62, v63
    s_nop 0
    v_readfirstlane_b32 s70, v62
    s_cmp_gt_u32 s70, 40
    s_cbranch_scc1 L_fw2_d
    s_sleep 16
    s_sub_u32 s62, s62, 17
    s_cselect_b32 s62, 0, s62
    s_cbranch_scc0 L_fw2
L_fw2_d:
L_xf_p:
    buffer_load_dwordx2 v[64:65], v58, s[56:59], s67 offen offset:0 sc1
    buffer_load_dwordx2 v[66:67], v58, s[56:59], s67 offen offset:384 sc1
    buffer_load_dwordx2 v[68:69], v58, s[56:59], s67 offen offset:768 sc1
    buffer_load_dwordx2 v[70:71], v58, s[56:59], s67 offen offset:1152 sc1
    buffer_load_dwordx2 v[72:73], v58, s[56:59], s67 offen offset:1536 sc1
    buffer_load_dwordx2 v[74:75], v58, s[56:59], s67 offen offset:1920 sc1
    buffer_load_dwordx2 v[76:77], v58, s[56:59], s67 offen offset:2304 sc1
    buffer_load_dwordx2 v[78:79], v58, s[56:59], s67 offen offset:2688 sc1
    s_waitcnt vmcnt(0)
    v_xor_b32 v64, s73, v64
    v_xor_b32 v65, s73, v65
    v_xor_b32 v66, s73, v66
    v_xor_b32 v67, s73, v67
    v_xor_b32 v68, s73, v68
    v_xor_b32 v69, s73, v69
    v_xor_b32 v70, s73, v70
    v_xor_b32 v71, s73, v71
    v_xor_b32 v72, s73, v72
    v_xor_b32 v73, s73, v73
    v_xor_b32 v74, s73, v74
    v_xor_b32 v75, s73, v75
    v_xor_b32 v76, s73, v76
    v_xor_b32 v77, s73, v77
    v_xor_b32 v78, s73, v78
    v_xor_b32 v79, s73, v79
    v_or_b32 v57, v64, v65
    v_or3_b32 v57, v57, v66, v67
    v_or3_b32 v57, v57, v68, v69
    v_or3_b32 v57, v57, v70, v71
    v_or3_b32 v57, v57, v72, v73
    v_or3_b32 v57, v57, v74, v75
    v_or3_b32 v57, v57, v76, v77
    v_or3_b32 v57, v57, v78, v79
    v_and_b32 v57, 0xff, v57
    v_cmp_ne_u32 vcc, 0, v57
    s_cbranch_vccz L_xf_d
    s_sleep 16
    s_sub_u32 s62, s62, 32
    s_cselect_b32 s62, 0, s62
    s_cbranch_scc0 L_xf_p
L_xf_d:
    v_add_f32 v64, v64, v66
    v_add_f32 v65, v65, v67
    v_add_f32 v64, v64, v68
    v_add_f32 v65, v65, v69
    v_add_f32 v64, v64, v70
    v_add_f32 v65, v65, v71
    v_add_f32 v64, v64, v72
    v_add_f32 v65, v65, v73
    v_add_f32 v64, v64, v74
    v_add_f32 v65, v65, v75
    v_add_f32 v64, v64, v76
    v_add_f32 v65, v65, v77
    v_add_f32 v64, v64, v78
    v_add_f32 v65, v65, v79
    s_mov_b64 exec, -1
    v_cvt_pk_bf16_f32 v52, v64, v65
    v_lshlrev_b32 v53, 16, v52
    v_and_b32 v54, 0xffff0000, v52
    v_mul_f32 v55, v53, v53
    v_mul_f32 v55, v55, v53
    v_fmamk_f32 v55, v55, 0x3d372713, v53
    v_mul_f32 v55, 0xc0135761, v55
    v_exp_f32 v55, v55
    s_nop 0
    v_add_f32 v55, 1.0, v55
    v_rcp_f32 v55, v55
    s_nop 0
    v_mul_f32 v55, v53, v55
    v_cvt_pk_bf16_f32 v55, v55, v55
    v_and_b32 v55, 0xffff0000, v55
    v_mul_f32 v55, v55, v54
    v_cvt_pk_bf16_f32 v55, v55, v55
    v_add_u32 v59, 163072, v60
    ds_write_b16 v59, v55
    v_lshrrev_b32 v40, 4, v1
    v_lshlrev_b32 v41, 3, v40
    v_add_u32 v41, 163072, v41
    v_lshrrev_b32 v42, 2, v1
    v_mul_u32_u24 v42, 160, v42
    v_and_b32 v43, 3, v1
    v_lshl_add_u32 v42, v43, 3, v42
    v_add_u32 v42, 129024, v42
    s_waitcnt lgkmcnt(0)
    ds_read_b64 v[32:33], v41 offset:0
    ds_read_b64 v[34:35], v41 offset:32
    ds_read_b64 v[36:37], v41 offset:64
    s_waitcnt lgkmcnt(0)
    ds_read_b64_tr_b16 v[64:65], v42 offset:0
    ds_read_b64_tr_b16 v[66:67], v42 offset:2560
    ds_read_b64_tr_b16 v[68:69], v42 offset:5120
    ds_read_b64_tr_b16 v[70:71], v42 offset:32
    ds_read_b64_tr_b16 v[72:73], v42 offset:2592
    ds_read_b64_tr_b16 v[74:75], v42 offset:5152
    ds_read_b64_tr_b16 v[76:77], v42 offset:64
    ds_read_b64_tr_b16 v[78:79], v42 offset:2624
    ds_read_b64_tr_b16 v[80:81], v42 offset:5184
    ds_read_b64_tr_b16 v[82:83], v42 offset:96
    ds_read_b64_tr_b16 v[84:85], v42 offset:2656
    ds_read_b64_tr_b16 v[86:87], v42 offset:5216
    ds_read_b64_tr_b16 v[88:89], v42 offset:128
    ds_read_b64_tr_b16 v[90:91], v42 offset:2688
    ds_read_b64_tr_b16 v[92:93], v42 offset:5248
    v_cmp_eq_u32 s[44:45], 1, v40
    v_cmp_eq_u32 s[46:47], 2, v40
    v_cmp_eq_u32 s[48:49], 3, v40
    s_waitcnt lgkmcnt(0)
    v_mfma_f32_16x16x16_bf16 v[96:99], v[32:33], v[64:65], 0
    v_mfma_f32_16x16x16_bf16 v[96:99], v[34:35], v[66:67], v[96:99]
    v_mfma_f32_16x16x16_bf16 v[96:99], v[36:37], v[68:69], v[96:99]
    v_mfma_f32_16x16x16_bf16 v[100:103], v[32:33], v[70:71], 0
    v_mfma_f32_16x16x16_bf16 v[100:103], v[34:35], v[72:73], v[100:103]
    v_mfma_f32_16x16x16_bf16 v[100:103], v[36:37], v[74:75], v[100:103]
    v_mfma_f32_16x16x16_bf16 v[104:107], v[32:33], v[76:77], 0
    v_mfma_f32_16x16x16_bf16 v[104:107], v[34:35], v[78:79], v[104:107]
    v_mfma_f32_16x16x16_bf16 v[104:107], v[36:37], v[80:81], v[104:107]
    v_mfma_f32_16x16x16_bf16 v[108:111], v[32:33], v[82:83], 0
    v_mfma_f32_16x16x16_bf16 v[108:111], v[34:35], v[84:85], v[108:111]
    v_mfma_f32_16x16x16_bf16 v[108:111], v[36:37], v[86:87], v[108:111]
    v_mfma_f32_16x16x16_bf16 v[112:115], v[32:33], v[88:89], 0
    v_mfma_f32_16x16x16_bf16 v[112:115], v[34:35], v[90:91], v[112:115]
    v_mfma_f32_16x16x16_bf16 v[112:115], v[36:37], v[92:93], v[112:115]
    v_cndmask_b32 v140, v96, v100, s[44:45]
    s_nop 0
    v_cndmask_b32 v140, v140, v104, s[46:47]
    s_nop 1
    v_cndmask_b32 v140, v140, v108, s[48:49]
    s_nop 1
    v_mov_b32 v141, v112
    v_and_or_b32 v140, v140, v49, s73
    v_and_or_b32 v141, v141, v49, s73
    s_branch L_t2
L_stats:
    v_mov_b32 v12, -1
    v_mov_b32 v13, -1
    v_mov_b32 v14, -1
    v_mov_b32 v15, -1
    s_mul_i32 s67, s63, 12288
    s_mul_i32 s68, s66, 384
    s_add_u32 s67, s67, s68
    s_add_u32 s67, s67, 294912
    s_mov_b64 exec, 0xffffff
    buffer_store_dwordx4 v[12:15], v5, s[56:59], s67 offen sc1
    s_mov_b64 exec, -1
    s_waitcnt vmcnt(0)
    v_lshlrev_b32 v39, 5, v1
    v_add_u32 v39, 152064, v39
    v_and_b32 v41, 31, v1
    v_lshlrev_b32 v41, 5, v41
    s_lshl_b32 s67, s63, 11
    s_add_u32 s67, s67, 1376256
    s_mov_b32 s72, 0
    s_mov_b32 s41, 3
    s_mov_b32 s71, 96
L_sg:
L_sw:
    ds_read_b64 v[62:63], v7 offset:16
    s_waitcnt lgkmcnt(0)
    v_min_u32 v62, v62, v63
    s_nop 0
    v_readfirstlane_b32 s70, v62
    s_cmp_gt_u32 s70, s71
    s_cbranch_scc1 L_sw_d
    s_sleep 16
    s_sub_u32 s62, s62, 17
    s_cselect_b32 s62, 0, s62
    s_cbranch_scc0 L_sw
L_sw_d:
    ds_read_b32 v48, v7 offset:12
    s_waitcnt lgkmcnt(0)
    v_readfirstlane_b32 s54, v48
    ds_read_b32 v48, v7 offset:28
    s_waitcnt lgkmcnt(0)
    v_readfirstlane_b32 s74, v48
    s_and_b32 s73, s74, 0xff
    v_mov_b32 v40, v39
    s_mov_b32 s42, s41
L_s1:
    ds_read_b128 v[8:11], v40
    ds_read_b128 v[12:15], v40 offset:16
    s_waitcnt lgkmcnt(0)
    v_lshlrev_b32 v16, 16, v8
    v_and_b32 v17, 0xffff0000, v8
    v_lshlrev_b32 v18, 16, v9
    v_and_b32 v19, 0xffff0000, v9
    v_lshlrev_b32 v20, 16, v10
    v_and_b32 v21, 0xffff0000, v10
    v_lshlrev_b32 v22, 16, v11
    v_and_b32 v23, 0xffff0000, v11
    v_lshlrev_b32 v24, 16, v12
    v_and_b32 v25, 0xffff0000, v12
    v_lshlrev_b32 v26, 16, v13
    v_and_b32 v27, 0xffff0000, v13
    v_lshlrev_b32 v28, 16, v14
    v_and_b32 v29, 0xffff0000, v14
    v_lshlrev_b32 v30, 16, v15
    v_and_b32 v31, 0xffff0000, v15
    v_max3_f32 v44, v16, v17, v18
    v_max3_f32 v44, v44, v19, v20
    v_max3_f32 v44, v44, v21, v22
    v_max3_f32 v44, v44, v23, v24
    v_max3_f32 v44, v44, v25, v26
    v_max3_f32 v44, v44, v27, v28
    v_max3_f32 v44, v44, v29, v30
    v_max_f32 v44, v44, v31
    s_nop 1
    v_max_f32_dpp v44, v44, v44 quad_perm:[1,0,3,2] row_mask:0xf bank_mask:0xf
    s_nop 1
    v_max_f32_dpp v44, v44, v44 quad_perm:[2,3,0,1] row_mask:0xf bank_mask:0xf
    s_nop 1
    v_max_f32_dpp v44, v44, v44 row_half_mirror row_mask:0xf bank_mask:0xf
    s_nop 1
    v_max_f32_dpp v44, v44, v44 row_ror:8 row_mask:0xf bank_mask:0xf
    v_mov_b32 v48, v44
    s_nop 1
    v_permlane16_swap_b32 v44, v48
    v_max_f32 v44, v44, v48
    v_mov_b32 v48, v44
    s_nop 1
    v_permlane32_swap_b32 v44, v48
    v_max_f32 v44, v44, v48
    v_mov_b32 v45, 0
    v_sub_f32 v48, v16, v44
    v_mul_f32 v48, 0x3fb8aa3b, v48
    v_exp_f32 v48, v48
    s_nop 0
    v_add_f32 v45, v45, v48
    v_sub_f32 v48, v17, v44
    v_mul_f32 v48, 0x3fb8aa3b, v48
    v_exp_f32 v48, v48
    s_nop 0
    v_add_f32 v45, v45, v48
    v_sub_f32 v48, v18, v44
    v_mul_f32 v48, 0x3fb8aa3b, v48
    v_exp_f32 v48, v48
    s_nop 0
    v_add_f32 v45, v45, v48
    v_sub_f32 v48, v19, v44
    v_mul_f32 v48, 0x3fb8aa3b, v48
    v_exp_f32 v48, v48
    s_nop 0
    v_add_f32 v45, v45, v48
    v_sub_f32 v48, v20, v44
    v_mul_f32 v48, 0x3fb8aa3b, v48
    v_exp_f32 v48, v48
    s_nop 0
    v_add_f32 v45, v45, v48
    v_sub_f32 v48, v21, v44
    v_mul_f32 v48, 0x3fb8aa3b, v48
    v_exp_f32 v48, v48
    s_nop 0
    v_add_f32 v45, v45, v48
    v_sub_f32 v48, v22, v44
    v_mul_f32 v48, 0x3fb8aa3b, v48
    v_exp_f32 v48, v48
    s_nop 0
    v_add_f32 v45, v45, v48
    v_sub_f32 v48, v23, v44
    v_mul_f32 v48, 0x3fb8aa3b, v48
    v_exp_f32 v48, v48
    s_nop 0
    v_add_f32 v45, v45, v48
    v_sub_f32 v48, v24, v44
    v_mul_f32 v48, 0x3fb8aa3b, v48
    v_exp_f32 v48, v48
    s_nop 0
    v_add_f32 v45, v45, v48
    v_sub_f32 v48, v25, v44
    v_mul_f32 v48, 0x3fb8aa3b, v48
    v_exp_f32 v48, v48
    s_nop 0
    v_add_f32 v45, v45, v48
    v_sub_f32 v48, v26, v44
    v_mul_f32 v48, 0x3fb8aa3b, v48
    v_exp_f32 v48, v48
    s_nop 0
    v_add_f32 v45, v45, v48
    v_sub_f32 v48, v27, v44
    v_mul_f32 v48, 0x3fb8aa3b, v48
    v_exp_f32 v48, v48
    s_nop 0
    v_add_f32 v45, v45, v48
    v_sub_f32 v48, v28, v44
    v_mul_f32 v48, 0x3fb8aa3b, v48
    v_exp_f32 v48, v48
    s_nop 0
    v_add_f32 v45, v45, v48
    v_sub_f32 v48, v29, v44
    v_mul_f32 v48, 0x3fb8aa3b, v48
    v_exp_f32 v48, v48
    s_nop 0
    v_add_f32 v45, v45, v48
    v_sub_f32 v48, v30, v44
    v_mul_f32 v48, 0x3fb8aa3b, v48
    v_exp_f32 v48, v48
    s_nop 0
    v_add_f32 v45, v45, v48
    v_sub_f32 v48, v31, v44
    v_mul_f32 v48, 0x3fb8aa3b, v48
    v_exp_f32 v48, v48
    s_nop 0
    v_add_f32 v45, v45, v48
    s_nop 1
    v_add_f32_dpp v45, v45, v45 quad_perm:[1,0,3,2] row_mask:0xf bank_mask:0xf
    s_nop 1
    v_add_f32_dpp v45, v45, v45 quad_perm:[2,3,0,1] row_mask:0xf bank_mask:0xf
    s_nop 1
    v_add_f32_dpp v45, v45, v45 row_half_mirror row_mask:0xf bank_mask:0xf
    s_nop 1
    v_add_f32_dpp v45, v45, v45 row_ror:8 row_mask:0xf bank_mask:0xf
    v_mov_b32 v48, v45
    s_nop 1
    v_permlane16_swap_b32 v45, v48
    v_add_f32 v45, v45, v48
    v_mov_b32 v48, v45
    s_nop 1
    v_permlane32_swap_b32 v45, v48
    v_add_f32 v45, v45, v48
    v_mov_b32 v64, v65
    v_mov_b32 v65, v66
    v_mov_b32 v66, v44
    v_mov_b32 v68, v69
    v_mov_b32 v69, v70
    v_mov_b32 v70, v45
    v_add_u32 v40, 2048, v40
    s_sub_u32 s42, s42, 1
    s_cmp_lg_u32 s42, 0
    s_cbranch_scc1 L_s1
    v_cmp_eq_u32 vcc, 1, v1
    v_mov_b32 v67, s74
    s_nop 0
    v_cndmask_b32 v64, v64, v68, vcc
    v_cndmask_b32 v65, v65, v69, vcc
    v_cndmask_b32 v66, v66, v70, vcc
    s_lshl_b32 s68, s66, 5
    s_add_u32 s68, s68, s67
    s_mov_b64 exec, 3
    s_cmp_lg_u32 s54, 2
    s_cbranch_scc1 L_ls4a
    buffer_store_dwordx4 v[64:67], v5, s[56:59], s68 offen
    s_branch L_ls4b
L_ls4a:
    buffer_store_dwordx4 v[64:67], v5, s[56:59], s68 offen sc1
L_ls4b:
    s_mov_b64 exec, -1
    s_add_u32 s71, s71, 14
L_sw2:
    ds_read_b64 v[62:63], v7 offset:16
    s_waitcnt lgkmcnt(0)
    v_min_u32 v62, v62, v63
    s_nop 0
    v_readfirstlane_b32 s70, v62
    s_cmp_gt_u32 s70, s71
    s_cbranch_scc1 L_sw2_d
    s_sleep 16
    s_sub_u32 s62, s62, 17
    s_cselect_b32 s62, 0, s62
    s_cbranch_scc0 L_sw2
L_sw2_d:
L_sp:
    buffer_load_dwordx4 v[72:75], v41, s[56:59], s67 offen sc1
    buffer_load_dwordx4 v[76:79], v41, s[56:59], s67 offen offset:16 sc1
    s_waitcnt vmcnt(0)
    v_xor_b32 v75, s74, v75
    v_xor_b32 v79, s74, v79
    v_or_b32 v75, v75, v79
    v_cmp_ne_u32 vcc, 0, v75
    s_cbranch_vccz L_sq
    s_sleep 32
    s_sub_u32 s62, s62, 48
    s_cselect_b32 s62, 0, s62
    s_cbranch_scc0 L_sp
L_sq:
    s_mov_b32 s42, s41
L_s2:
    v_add_u32 v40, -2048, v40
    ds_read_b128 v[8:11], v40
    ds_read_b128 v[12:15], v40 offset:16
    s_waitcnt lgkmcnt(0)
    v_lshlrev_b32 v16, 16, v8
    v_and_b32 v17, 0xffff0000, v8
    v_lshlrev_b32 v18, 16, v9
    v_and_b32 v19, 0xffff0000, v9
    v_lshlrev_b32 v20, 16, v10
    v_and_b32 v21, 0xffff0000, v10
    v_lshlrev_b32 v22, 16, v11
    v_and_b32 v23, 0xffff0000, v11
    v_lshlrev_b32 v24, 16, v12
    v_and_b32 v25, 0xffff0000, v12
    v_lshlrev_b32 v26, 16, v13
    v_and_b32 v27, 0xffff0000, v13
    v_lshlrev_b32 v28, 16, v14
    v_and_b32 v29, 0xffff0000, v14
    v_lshlrev_b32 v30, 16, v15
    v_and_b32 v31, 0xffff0000, v15
    v_mov_b32 v44, v74
    s_nop 1
    v_max_f32_dpp v44, v44, v44 quad_perm:[1,0,3,2] row_mask:0xf bank_mask:0xf
    s_nop 1
    v_max_f32_dpp v44, v44, v44 quad_perm:[2,3,0,1] row_mask:0xf bank_mask:0xf
    s_nop 1
    v_max_f32_dpp v44, v44, v44 row_half_mirror row_mask:0xf bank_mask:0xf
    s_nop 1
    v_max_f32_dpp v44, v44, v44 row_ror:8 row_mask:0xf bank_mask:0xf
    v_mov_b32 v48, v44
    s_nop 1
    v_permlane16_swap_b32 v44, v48
    v_max_f32 v44, v44, v48
    v_sub_f32 v48, v74, v44
    v_mul_f32 v48, 0x3fb8aa3b, v48
    v_exp_f32 v48, v48
    s_nop 0
    v_mul_f32 v45, v48, v78
    s_nop 1
    v_add_f32_dpp v45, v45, v45 quad_perm:[1,0,3,2] row_mask:0xf bank_mask:0xf
    s_nop 1
    v_add_f32_dpp v45, v45, v45 quad_perm:[2,3,0,1] row_mask:0xf bank_mask:0xf
    s_nop 1
    v_add_f32_dpp v45, v45, v45 row_half_mirror row_mask:0xf bank_mask:0xf
    s_nop 1
    v_add_f32_dpp v45, v45, v45 row_ror:8 row_mask:0xf bank_mask:0xf
    v_mov_b32 v48, v45
    s_nop 1
    v_permlane16_swap_b32 v45, v48
    v_add_f32 v45, v45, v48
    v_rcp_f32 v46, v45
    s_nop 0
    v_fma_f32 v48, -v45, v46, 1.0
    v_fmac_f32 v46, v48, v46
    v_sub_f32 v16, v16, v44
    v_mul_f32 v16, 0x3fb8aa3b, v16
    v_exp_f32 v16, v16
    s_nop 0
    v_mul_f32 v16, v16, v46
    v_sub_f32 v17, v17, v44
    v_mul_f32 v17, 0x3fb8aa3b, v17
    v_exp_f32 v17, v17
    s_nop 0
    v_mul_f32 v17, v17, v46
    v_sub_f32 v18, v18, v44
    v_mul_f32 v18, 0x3fb8aa3b, v18
    v_exp_f32 v18, v18
    s_nop 0
    v_mul_f32 v18, v18, v46
    v_sub_f32 v19, v19, v44
    v_mul_f32 v19, 0x3fb8aa3b, v19
    v_exp_f32 v19, v19
    s_nop 0
    v_mul_f32 v19, v19, v46
    v_sub_f32 v20, v20, v44
    v_mul_f32 v20, 0x3fb8aa3b, v20
    v_exp_f32 v20, v20
    s_nop 0
    v_mul_f32 v20, v20, v46
    v_sub_f32 v21, v21, v44
    v_mul_f32 v21, 0x3fb8aa3b, v21
    v_exp_f32 v21, v21
    s_nop 0
    v_mul_f32 v21, v21, v46
    v_sub_f32 v22, v22, v44
    v_mul_f32 v22, 0x3fb8aa3b, v22
    v_exp_f32 v22, v22
    s_nop 0
    v_mul_f32 v22, v22, v46
    v_sub_f32 v23, v23, v44
    v_mul_f32 v23, 0x3fb8aa3b, v23
    v_exp_f32 v23, v23
    s_nop 0
    v_mul_f32 v23, v23, v46
    v_sub_f32 v24, v24, v44
    v_mul_f32 v24, 0x3fb8aa3b, v24
    v_exp_f32 v24, v24
    s_nop 0
    v_mul_f32 v24, v24, v46
    v_sub_f32 v25, v25, v44
    v_mul_f32 v25, 0x3fb8aa3b, v25
    v_exp_f32 v25, v25
    s_nop 0
    v_mul_f32 v25, v25, v46
    v_sub_f32 v26, v26, v44
    v_mul_f32 v26, 0x3fb8aa3b, v26
    v_exp_f32 v26, v26
    s_nop 0
    v_mul_f32 v26, v26, v46
    v_sub_f32 v27, v27, v44
    v_mul_f32 v27, 0x3fb8aa3b, v27
    v_exp_f32 v27, v27
    s_nop 0
    v_mul_f32 v27, v27, v46
    v_sub_f32 v28, v28, v44
    v_mul_f32 v28, 0x3fb8aa3b, v28
    v_exp_f32 v28, v28
    s_nop 0
    v_mul_f32 v28, v28, v46
    v_sub_f32 v29, v29, v44
    v_mul_f32 v29, 0x3fb8aa3b, v29
    v_exp_f32 v29, v29
    s_nop 0
    v_mul_f32 v29, v29, v46
    v_sub_f32 v30, v30, v44
    v_mul_f32 v30, 0x3fb8aa3b, v30
    v_exp_f32 v30, v30
    s_nop 0
    v_mul_f32 v30, v30, v46
    v_sub_f32 v31, v31, v44
    v_mul_f32 v31, 0x3fb8aa3b, v31
    v_exp_f32 v31, v31
    s_nop 0
    v_mul_f32 v31, v31, v46
    v_cvt_pk_bf16_f32 v8, v16, v17
    v_cvt_pk_bf16_f32 v9, v18, v19
    v_cvt_pk_bf16_f32 v10, v20, v21
    v_cvt_pk_bf16_f32 v11, v22, v23
    v_cvt_pk_bf16_f32 v12, v24, v25
    v_cvt_pk_bf16_f32 v13, v26, v27
    v_cvt_pk_bf16_f32 v14, v28, v29
    v_cvt_pk_bf16_f32 v15, v30, v31
    ds_write_b128 v40, v[8:11]
    ds_write_b128 v40, v[12:15] offset:16
    v_mov_b32 v74, v73
    v_mov_b32 v73, v72
    v_mov_b32 v78, v77
    v_mov_b32 v77, v76
    s_waitcnt lgkmcnt(0)
    s_sub_u32 s42, s42, 1
    s_cmp_lg_u32 s42, 0
    s_cbranch_scc1 L_s2
    s_add_u32 s72, s72, s41
    v_mov_b32 v48, s72
    ds_write_b32 v7, v48 offset:8
    v_add_u32 v39, 6144, v39
    s_add_u32 s67, s67, 1024
    s_mov_b32 s71, 128
    s_mov_b32 s41, 1
    s_cmp_lt_u32 s72, 4
    s_cbranch_scc1 L_sg
L_t2:
    v_lshrrev_b32 v40, 4, v1
    v_and_b32 v42, 15, v1
    v_mul_u32_u24 v47, 8192, v40
    v_lshl_add_u32 v47, v42, 2, v47
    v_bfe_u32 v41, v1, 3, 1
    v_lshl_add_u32 v41, v40, 2, v41
    v_bfe_u32 v43, v1, 2, 1
    v_lshl_add_u32 v41, v43, 4, v41
    v_mul_u32_u24 v41, 160, v41
    v_and_b32 v43, 3, v1
    v_lshl_add_u32 v41, v43, 3, v41
    v_add_u32 v41, 98304, v41
    v_lshlrev_b32 v43, 4, v1
    s_mul_i32 s43, s61, 40960
    s_add_u32 s43, s43, 393216
    s_and_b32 s41, s3, 3
    s_add_u32 s42, s41, 1
    s_cmp_ge_u32 s60, 24
    s_cbranch_scc1 L_t2s
    s_cmp_eq_u32 s3, 5
    s_cbranch_scc1 L_fpub
    s_mov_b32 s41, 0
    s_cmp_lg_u32 s3, 7
    s_cbranch_scc1 L_t2x
L_t2s:
L_t2a:
    ds_read_b64 v[62:63], v7 offset:16
    s_waitcnt lgkmcnt(0)
    v_min_u32 v62, v62, v63
    s_nop 0
    v_readfirstlane_b32 s70, v62
    s_cmp_gt_u32 s70, 0
    s_cbranch_scc1 L_t2a_d
    s_sleep 32
    s_sub_u32 s62, s62, 33
    s_cselect_b32 s62, 0, s62
    s_cbranch_scc0 L_t2a
L_t2a_d:
    ds_read_b32 v62, v7 offset:28
    s_waitcnt lgkmcnt(0)
    v_readfirstlane_b32 s74, v62
    s_and_b32 s73, s74, 0xff
    s_waitcnt vmcnt(0)
    s_lshr_b32 s71, s60, 3
    s_lshl_b32 s71, s71, 5
    s_add_u32 s71, s71, 172
    s_min_u32 s71, s71, 250
    v_mov_b32 v8, 0
    v_mov_b32 v9, 0
    v_mov_b32 v10, 0
    v_mov_b32 v11, 0
    v_mov_b32 v12, 0
    v_mov_b32 v13, 0
    v_mov_b32 v14, 0
    v_mov_b32 v15, 0
    v_mov_b32 v16, 0
    v_mov_b32 v17, 0
    v_mov_b32 v18, 0
    v_mov_b32 v19, 0
    v_mov_b32 v20, 0
    v_mov_b32 v21, 0
    v_mov_b32 v22, 0
    v_mov_b32 v23, 0
    v_mov_b32 v24, 0
    v_mov_b32 v25, 0
    v_mov_b32 v26, 0
    v_mov_b32 v27, 0
L_t2i:
    s_and_b32 s67, s41, 1
    s_lshr_b32 s68, s41, 1
    s_mul_i32 s69, s68, 15360
    v_add_u32 v44, s69, v41
    ds_read_b64_tr_b16 v[64:65], v44 offset:0
    ds_read_b64_tr_b16 v[66:67], v44 offset:320
    ds_read_b64_tr_b16 v[68:69], v44 offset:32
    ds_read_b64_tr_b16 v[70:71], v44 offset:352
    ds_read_b64_tr_b16 v[72:73], v44 offset:64
    ds_read_b64_tr_b16 v[74:75], v44 offset:384
    ds_read_b64_tr_b16 v[76:77], v44 offset:96
    ds_read_b64_tr_b16 v[78:79], v44 offset:416
    ds_read_b64_tr_b16 v[80:81], v44 offset:128
    ds_read_b64_tr_b16 v[82:83], v44 offset:448
    s_waitcnt lgkmcnt(0)
    ds_read_b64_tr_b16 v[84:85], v44 offset:5120
    ds_read_b64_tr_b16 v[86:87], v44 offset:5440
    ds_read_b64_tr_b16 v[88:89], v44 offset:5152
    ds_read_b64_tr_b16 v[90:91], v44 offset:5472
    ds_read_b64_tr_b16 v[92:93], v44 offset:5184
    ds_read_b64_tr_b16 v[94:95], v44 offset:5504
    ds_read_b64_tr_b16 v[96:97], v44 offset:5216
    ds_read_b64_tr_b16 v[98:99], v44 offset:5536
    ds_read_b64_tr_b16 v[100:101], v44 offset:5248
    ds_read_b64_tr_b16 v[102:103], v44 offset:5568
    s_waitcnt lgkmcnt(0)
    ds_read_b64_tr_b16 v[104:105], v44 offset:10240
    ds_read_b64_tr_b16 v[106:107], v44 offset:10560
    ds_read_b64_tr_b16 v[108:109], v44 offset:10272
    ds_read_b64_tr_b16 v[110:111], v44 offset:10592
    ds_read_b64_tr_b16 v[112:113], v44 offset:10304
    ds_read_b64_tr_b16 v[114:115], v44 offset:10624
    ds_read_b64_tr_b16 v[116:117], v44 offset:10336
    ds_read_b64_tr_b16 v[118:119], v44 offset:10656
    ds_read_b64_tr_b16 v[120:121], v44 offset:10368
    ds_read_b64_tr_b16 v[122:123], v44 offset:10688
    s_waitcnt lgkmcnt(0)
    s_mul_i32 s67, s67, 6144
    s_mul_i32 s68, s68, 3072
    s_add_u32 s67, s67, s68
    s_mul_i32 s68, s60, 12288
    s_add_u32 s67, s67, s68
    s_lshl_b32 s68, s63, 2
    s_add_u32 s68, s68, s41
    s_add_u32 s68, s68, 64
    s_add_u32 s69, s60, 32
    s_cmp_ge_u32 s60, 24
    s_cselect_b32 s68, s68, s69
    s_lshl_b32 s68, s68, 6
    s_add_u32 s68, s68, s43
    s_add_u32 s69, s68, 32768
L_t2b:
    ds_read_b64 v[62:63], v7 offset:16
    s_waitcnt lgkmcnt(0)
    v_min_u32 v62, v62, v63
    s_nop 0
    v_readfirstlane_b32 s70, v62
    s_cmp_gt_u32 s70, s71
    s_cbranch_scc1 L_t2b_d
    s_sleep 32
    s_sub_u32 s62, s62, 33
    s_cselect_b32 s62, 0, s62
    s_cbranch_scc0 L_t2b
L_t2b_d:
    s_cmp_lg_u32 s71, 250
    s_cbranch_scc1 L_t2f
    s_cmp_lg_u32 s3, 5
    s_cbranch_scc1 L_t2c
L_fpub:
L_fpa:
    ds_read_b32 v62, v7 offset:0
    s_waitcnt lgkmcnt(0)
    v_readfirstlane_b32 s70, v62
    s_cmp_gt_u32 s70, 248
    s_cbranch_scc1 L_fpa_d
    s_sleep 32
    s_sub_u32 s62, s62, 33
    s_cselect_b32 s62, 0, s62
    s_cbranch_scc0 L_fpa
L_fpa_d:
L_fpb:
    ds_read_b32 v62, v7 offset:0
    s_waitcnt lgkmcnt(0)
    v_readfirstlane_b32 s70, v62
    s_cmp_gt_u32 s70, 253
    s_cbranch_scc1 L_fpb_d
    s_sleep 1
    s_sub_u32 s62, s62, 2
    s_cselect_b32 s62, 0, s62
    s_cbranch_scc0 L_fpb
L_fpb_d:
    s_lshl_b32 s44, s60, 6
    s_add_u32 s44, s44, s43
    s_add_u32 s45, s44, 32768
    buffer_store_dword v140, v47, s[56:59], s44 offen sc1
    s_mov_b64 exec, 0xffff
    buffer_store_dword v141, v47, s[56:59], s45 offen sc1
    s_mov_b64 exec, -1
    s_cmp_lt_u32 s60, 24
    s_cbranch_scc1 L_t2x
L_t2c:
    ds_read_b64 v[62:63], v7 offset:16
    s_waitcnt lgkmcnt(0)
    v_min_u32 v62, v62, v63
    s_nop 0
    v_readfirstlane_b32 s70, v62
    s_cmp_gt_u32 s70, 255
    s_cbranch_scc1 L_t2c_d
    s_sub_u32 s62, s62, 1
    s_cselect_b32 s62, 0, s62
    s_cbranch_scc0 L_t2c
L_t2c_d:
L_t2p:
    buffer_load_dwordx4 v[128:131], v43, s[56:59], s67 offen offset:0 sc1
    buffer_load_dwordx4 v[132:135], v43, s[56:59], s67 offen offset:1024 sc1
    buffer_load_dwordx4 v[136:139], v43, s[56:59], s67 offen offset:2048 sc1
    s_waitcnt vmcnt(2)
    v_max3_u32 v50, v128, v129, v130
    s_waitcnt vmcnt(1)
    v_max3_u32 v50, v50, v131, v132
    v_max3_u32 v50, v50, v133, v134
    s_waitcnt vmcnt(0)
    v_max3_u32 v51, v135, v136, v137
    v_max3_u32 v50, v50, v138, v139
    v_max_u32 v50, v50, v51
    v_cmp_eq_u32 vcc, -1, v50
    s_cbranch_vccz L_t2g
    s_sub_u32 s62, s62, 16
    s_cselect_b32 s62, 0, s62
    s_cbranch_scc0 L_t2p
L_t2g:
    v_mfma_f32_16x16x32_bf16 v[24:27], v[128:131], v[80:83], v[24:27]
    v_mfma_f32_16x16x32_bf16 v[24:27], v[132:135], v[100:103], v[24:27]
    v_mfma_f32_16x16x32_bf16 v[24:27], v[136:139], v[120:123], v[24:27]
    v_mfma_f32_16x16x32_bf16 v[8:11], v[128:131], v[64:67], v[8:11]
    v_mfma_f32_16x16x32_bf16 v[8:11], v[132:135], v[84:87], v[8:11]
    v_mfma_f32_16x16x32_bf16 v[8:11], v[136:139], v[104:107], v[8:11]
    v_mfma_f32_16x16x32_bf16 v[12:15], v[128:131], v[68:71], v[12:15]
    v_mfma_f32_16x16x32_bf16 v[12:15], v[132:135], v[88:91], v[12:15]
    v_mfma_f32_16x16x32_bf16 v[12:15], v[136:139], v[108:111], v[12:15]
    v_mfma_f32_16x16x32_bf16 v[16:19], v[128:131], v[72:75], v[16:19]
    v_mfma_f32_16x16x32_bf16 v[16:19], v[132:135], v[92:95], v[16:19]
    v_mfma_f32_16x16x32_bf16 v[16:19], v[136:139], v[112:115], v[16:19]
    v_add_f32 v32, v24, v25
    v_add_f32 v37, v26, v27
    v_add_f32 v32, v32, v37
    v_mfma_f32_16x16x32_bf16 v[20:23], v[128:131], v[76:79], v[20:23]
    v_mfma_f32_16x16x32_bf16 v[20:23], v[132:135], v[96:99], v[20:23]
    v_mfma_f32_16x16x32_bf16 v[20:23], v[136:139], v[116:119], v[20:23]
    v_add_f32 v28, v8, v9
    v_add_f32 v33, v10, v11
    v_add_f32 v28, v28, v33
    s_add_u32 s41, s41, 1
    s_cmp_lt_u32 s41, s42
    s_cbranch_scc1 L_t2i
    v_mov_b32 v38, v32
    v_add_f32 v29, v12, v13
    v_add_f32 v34, v14, v15
    v_add_f32 v29, v29, v34
    v_permlane16_swap_b32 v32, v38
    v_add_f32 v30, v16, v17
    v_add_f32 v35, v18, v19
    v_add_f32 v30, v30, v35
    v_add_f32 v32, v32, v38
    v_permlane16_swap_b32 v28, v29
    v_mov_b32 v38, v32
    v_add_f32 v31, v20, v21
    v_add_f32 v36, v22, v23
    v_add_f32 v31, v31, v36
    v_add_f32 v28, v28, v29
    v_permlane32_swap_b32 v32, v38
    v_permlane16_swap_b32 v30, v31
    v_add_f32 v24, v32, v38
    v_add_f32 v30, v30, v31
    s_nop 1
    v_permlane32_swap_b32 v28, v30
    v_add_f32 v8, v28, v30
    v_and_or_b32 v8, v8, v49, s73
    v_and_or_b32 v24, v24, v49, s73
    s_cmp_ge_u32 s60, 24
    s_cbranch_scc1 L_t2e_d
L_t2d:
    ds_read_b32 v62, v7 offset:0
    s_waitcnt lgkmcnt(0)
    v_readfirstlane_b32 s70, v62
    s_cmp_gt_u32 s70, 248
    s_cbranch_scc1 L_t2d_d
    s_sleep 32
    s_sub_u32 s62, s62, 33
    s_cselect_b32 s62, 0, s62
    s_cbranch_scc0 L_t2d
L_t2d_d:
L_t2e:
    ds_read_b32 v62, v7 offset:0
    s_waitcnt lgkmcnt(0)
    v_readfirstlane_b32 s70, v62
    s_cmp_gt_u32 s70, 253
    s_cbranch_scc1 L_t2e_d
    s_sleep 1
    s_sub_u32 s62, s62, 2
    s_cselect_b32 s62, 0, s62
    s_cbranch_scc0 L_t2e
L_t2e_d:
    buffer_store_dword v8, v47, s[56:59], s68 offen sc1
    s_mov_b64 exec, 0xffff
    buffer_store_dword v24, v47, s[56:59], s69 offen sc1
    s_endpgm
L_t2f:
    s_cmp_lg_u32 s41, 0
    s_cbranch_scc1 L_t2p
    s_lshl_b32 s44, s60, 8
    s_add_u32 s44, s44, 1441792
    v_lshlrev_b32 v45, 2, v1
L_t2fp:
    buffer_load_dword v46, v45, s[56:59], s44 offen sc1
    s_waitcnt vmcnt(0)
    v_cmp_ne_u32 vcc, s74, v46
    s_cbranch_vccz L_t2fq
    s_sleep 32
    s_sub_u32 s62, s62, 48
    s_cselect_b32 s62, 0, s62
    s_cbranch_scc0 L_t2fp
L_t2fq:
    s_branch L_t2p
L_t2x:
    s_lshl_b32 s40, s61, 3
    s_add_u32 s40, s40, s60
    s_cmp_lt_u32 s60, 8
    s_cselect_b32 s40, s40, 40
    s_cmp_eq_u32 s3, 4
    s_cselect_b32 s40, s40, 40
    s_cmp_lt_u32 s40, 40
    s_cbranch_scc1 L_t3
    s_endpgm
L_fb:
    s_add_u32 s40, s26, 1409024
    s_addc_u32 s41, s27, 0
    s_cmp_ge_u32 s63, 4
    s_cbranch_scc1 L_fbi
    s_lshl_b32 s67, s66, 2
    s_add_u32 s67, s67, s63
    s_lshl_b32 s67, s67, 8
    s_add_u32 s67, s67, 1409024
    v_mov_b32 v8, 0
    s_mov_b64 exec, 0xffff
    buffer_store_dword v8, v6, s[56:59], s67 offen sc1
    s_mov_b64 exec, -1
L_fbi:
    s_lshl_b32 s44, s63, 8
    s_add_u32 s44, s44, 1447936
    s_lshl_b32 s45, s66, 2
    s_add_u32 s45, s45, s44
    v_and_b32 v10, 31, v1
    v_lshlrev_b32 v10, 2, v10
    buffer_load_dword v9, v10, s[56:59], s44 offen
    s_and_b32 s71, s66, 3
    s_add_u32 s71, s71, 11
    s_mov_b32 s46, 0x8000
    s_mov_b32 s47, 0
    s_mul_i32 s67, s66, 37
    s_lshr_b32 s67, s67, 8
    s_mul_i32 s67, s67, 7
    s_sub_u32 s48, s66, s67
L_fbq:
    ds_read_b32 v62, v7 offset:4
    s_waitcnt lgkmcnt(0)
    v_readfirstlane_b32 s70, v62
    s_cmp_gt_u32 s70, 0
    s_cbranch_scc1 L_fbq_d
    s_sleep 8
    s_sub_u32 s62, s62, 9
    s_cselect_b32 s62, 0, s62
    s_cbranch_scc0 L_fbq
L_fbq_d:
    ds_read_b32 v62, v7 offset:28
    s_waitcnt lgkmcnt(0)
    v_readfirstlane_b32 s74, v62
    s_and_b32 s73, s74, 0xff
L_fbl:
L_fbw:
    ds_read_b32 v62, v7 offset:0
    s_waitcnt lgkmcnt(0)
    v_readfirstlane_b32 s70, v62
    s_cmp_gt_u32 s70, s71
    s_cbranch_scc1 L_fbw_d
    s_sleep 1
    s_sub_u32 s62, s62, 2
    s_cselect_b32 s62, 0, s62
    s_cbranch_scc0 L_fbw
L_fbw_d:
    s_add_u32 s67, s71, s46
    s_add_u32 s67, s67, s74
    v_mov_b32 v8, s67
    s_mov_b64 exec, 1
    buffer_store_dword v8, off, s[56:59], s45
    s_mov_b64 exec, -1
    buffer_load_dword v9, v10, s[56:59], s44 offen sc1
    s_cmp_lg_u32 s47, 0
    s_cbranch_scc1 L_fbn
    s_add_u32 s67, s48, 1
    s_xor_b32 s68, s67, s63
    s_min_u32 s68, s68, s63
    s_flbit_i32_b32 s67, s67
    s_sub_u32 s67, 31, s67
    s_bfm_b32 s69, s67, 0
    s_and_b32 s49, s68, s69
    s_lshr_b32 s68, s68, 1
    s_andn2_b32 s68, s68, s69
    s_or_b32 s49, s49, s68
    s_lshl_b32 s67, s66, 2
    s_add_u32 s49, s49, s67
    s_lshl_b32 s49, s49, 8
    s_mov_b32 s46, 1
    s_atomic_add s46, s[40:41], s49 glc
    s_add_u32 s48, s48, 1
    s_cmp_eq_u32 s48, 7
    s_cselect_b32 s48, 0, s48
    s_mov_b32 s47, 8
    s_waitcnt lgkmcnt(0)
    s_add_u32 s40, s40, 4
    s_addc_u32 s41, s41, 0
    s_min_u32 s46, s46, 1
    s_lshl_b32 s46, s46, 16
L_fbn:
    s_sub_u32 s47, s47, 1
    s_add_u32 s67, s71, 32766
    v_mov_b32 v11, s67
    s_waitcnt vmcnt(0)
    v_subrev_u32 v9, s74, v9
    v_and_b32 v12, 0xfffe7e00, v9
    v_cmp_eq_u32 vcc, 0, v12
    s_nop 1
    v_cndmask_b32 v9, v11, v9, vcc
    s_nop 1
    v_add_u32_dpp v9, v9, v9 quad_perm:[1,0,3,2] row_mask:0xf bank_mask:0xf
    s_nop 1
    v_add_u32_dpp v9, v9, v9 quad_perm:[2,3,0,1] row_mask:0xf bank_mask:0xf
    s_nop 1
    v_add_u32_dpp v9, v9, v9 row_half_mirror row_mask:0xf bank_mask:0xf
    s_nop 1
    v_add_u32_dpp v9, v9, v9 row_ror:8 row_mask:0xf bank_mask:0xf
    v_mov_b32 v12, v9
    s_nop 1
    v_permlane16_swap_b32 v9, v12
    v_add_u32 v9, v9, v12
    s_nop 0
    v_readfirstlane_b32 s67, v9
    s_and_b32 s68, s67, 0x7fff
    s_lshr_b32 s67, s67, 15
    s_lshl_b32 s69, s71, 5
    s_sub_u32 s68, s68, s69
    s_add_u32 s68, s68, 60
    s_mul_i32 s68, s68, 32
    s_sub_u32 s67, s67, 32
    s_mul_i32 s67, s67, 24
    s_add_u32 s67, s67, s68
    s_add_u32 s67, s67, 256
    s_ashr_i32 s67, s67, 9
    s_max_i32 s67, s67, -3
    s_min_i32 s67, s67, 4
    v_mov_b32 v8, s67
    ds_write_b32 v7, v8 offset:24
    s_add_u32 s71, s71, 4
    s_cmp_lt_u32 s71, 251
    s_cbranch_scc1 L_fbl
    s_waitcnt lgkmcnt(0)
    s_endpgm
L_t3:
    s_mov_b32 s28, s4
    s_mov_b32 s29, s5
    s_mov_b32 s30, 1280
    s_mov_b32 s31, 0x20000
    s_mov_b32 s48, s22
    s_mov_b32 s49, s23
    s_mov_b32 s50, 1280
    s_mov_b32 s51, 0x20000
    s_mul_i32 s67, s40, 8192
    s_add_u32 s67, s67, 395264
    v_lshlrev_b32 v5, 4, v1
    v_and_b32 v6, 3, v1
    v_lshl_add_u32 v6, v6, 2, v40
    v_lshlrev_b32 v6, 1, v6
    s_lshl_b32 s68, s40, 5
    buffer_load_ushort v41, v6, s[28:31], s68 offen
    v_mov_b32 v43, s74
    s_mov_b32 s72, 0
    s_mov_b32 s69, 0
L_t3w:
    ds_read_b64 v[62:63], v7 offset:16
    s_waitcnt lgkmcnt(0)
    v_min_u32 v62, v62, v63
    s_nop 0
    v_readfirstlane_b32 s70, v62
    s_cmp_gt_u32 s70, 250
    s_cbranch_scc1 L_t3w_d
    s_sleep 32
    s_sub_u32 s62, s62, 33
    s_cselect_b32 s62, 0, s62
    s_cbranch_scc0 L_t3w
L_t3w_d:
L_t3x:
    ds_read_b64 v[62:63], v7 offset:16
    s_waitcnt lgkmcnt(0)
    v_min_u32 v62, v62, v63
    s_nop 0
    v_readfirstlane_b32 s70, v62
    s_cmp_gt_u32 s70, 255
    s_cbranch_scc1 L_t3x_d
    s_sleep 1
    s_sub_u32 s62, s62, 2
    s_cselect_b32 s62, 0, s62
    s_cbranch_scc0 L_t3x
L_t3x_d:
L_t3g:
    v_mov_b32 v12, 0
    v_mov_b32 v13, 0
    v_mov_b32 v14, 0
    v_mov_b32 v15, 0
L_t3p:
    buffer_load_dwordx4 v[8:11], v5, s[56:59], s67 offen sc1
    s_mov_b32 exec_hi, s69
    buffer_load_dwordx4 v[12:15], v5, s[56:59], s67 offen offset:1024 sc1
    s_mov_b32 exec_hi, -1
    s_waitcnt vmcnt(1)
    v_xor_b32 v8, s73, v8
    v_xor_b32 v9, s73, v9
    v_xor_b32 v10, s73, v10
    v_xor_b32 v11, s73, v11
    v_or_b32 v24, v8, v9
    v_or3_b32 v24, v24, v10, v11
    s_waitcnt vmcnt(0)
    s_mov_b32 exec_hi, s69
    v_xor_b32 v12, s73, v12
    v_xor_b32 v13, s73, v13
    v_xor_b32 v14, s73, v14
    v_xor_b32 v15, s73, v15
    v_or3_b32 v24, v24, v12, v13
    v_or3_b32 v24, v24, v14, v15
    s_mov_b32 exec_hi, -1
    v_and_b32 v24, 0xff, v24
    v_cmp_ne_u32 vcc, 0, v24
    s_cbranch_vccz L_t3q
    s_sub_u32 s62, s62, 16
    s_cselect_b32 s62, 0, s62
    s_cbranch_scc0 L_t3p
L_t3q:
    v_add_f32 v8, v8, v12
    v_add_f32 v9, v9, v13
    v_add_f32 v10, v10, v14
    v_add_f32 v11, v11, v15
    s_nop 0
    v_permlane32_swap_b32 v8, v10
    v_permlane32_swap_b32 v9, v11
    v_add_f32 v8, v8, v10
    v_add_f32 v9, v9, v11
    s_nop 1
    v_permlane16_swap_b32 v8, v9
    v_add_f32 v8, v8, v9
    s_nop 1
    v_add_f32_dpp v8, v8, v8 row_ror:8 row_mask:0xf bank_mask:0xf
    s_nop 1
    v_add_f32_dpp v8, v8, v8 row_ror:4 row_mask:0xf bank_mask:0xf
    s_cmp_eq_u32 s72, 2
    s_cbranch_scc1 L_t3o
    s_add_u32 s72, s72, 1
    s_mov_b32 s69, -1
    s_cmp_eq_u32 s72, 2
    s_cbranch_scc1 L_t3f
    v_mov_b32 v26, v8
    v_lshlrev_b32 v41, 16, v41
    s_sub_u32 s67, s67, 2048
    s_branch L_t3p
L_t3f:
    v_cvt_pk_bf16_f32 v16, v8, v8
    v_and_b32 v16, 0xffff0000, v16
    s_add_u32 s67, s67, 4096
    s_branch L_t3p
L_t3o:
    v_add_f32 v8, v26, v8
    v_cvt_pk_bf16_f32 v8, v8, v8
    v_and_b32 v8, 0xffff0000, v8
    v_add_f32 v8, v41, v8
    v_cvt_pk_bf16_f32 v8, v8, v8
    v_and_b32 v8, 0xffff0000, v8
    v_add_f32 v8, v8, v16
    v_cvt_pk_bf16_f32 v8, v8, v8
    s_mov_b32 exec_lo, 0x000f000f
    s_mov_b32 exec_hi, 0x000f000f
    buffer_store_short v8, v6, s[48:51], s68 offen
    s_cmp_lg_u32 s2, 0
    s_cbranch_scc1 L_t3z
    s_mov_b64 exec, 1
    s_mov_b32 s67, 1392640
    buffer_store_dword v43, off, s[56:59], s67
L_t3z:
    s_endpgm
L_end:
    s_endpgm
.section .rodata,"a"
.p2align 6
.amdhsa_kernel parallel_sum__mha_block_cached__geglu_ffn__decode_kernel
  .amdhsa_next_free_vgpr 192
  .amdhsa_next_free_sgpr 96
  .amdhsa_accum_offset 192
  .amdhsa_group_segment_fixed_size 0
  .amdhsa_kernarg_size 96
  .amdhsa_user_sgpr_count 2
  .amdhsa_user_sgpr_kernarg_segment_ptr 1
  .amdhsa_system_sgpr_workgroup_id_x 1
  .amdhsa_float_denorm_mode_32 3
.end_amdhsa_kernel
```
